```python
import torch

def _softmax(x, axis=-1):
    return torch.softmax(x, dim=axis)

def _gelu(x):
    return torch.nn.functional.gelu(x, approximate='tanh')

def _silu(x):
    return torch.nn.functional.silu(x)

def _sigmoid(x):
    return torch.sigmoid(x)

def _layernorm(x, axis=-1, eps=1e-05):
    m = x.mean(dim=axis, keepdim=True)
    v = x.var(dim=axis, keepdim=True, unbiased=False)
    return (x - m) / torch.sqrt(v + eps)

def _scatter_add(tgt, idx, src, axis=0):
    return tgt.clone().index_add_(axis, idx, src)

def _segment_sum(src, seg, n):
    out = torch.zeros((n,) + src.shape[1:], dtype=src.dtype)
    return out.index_add_(0, seg, src)

def _pad(x, pw):
    flat = tuple((v for pair in reversed(pw) for v in pair))
    return torch.nn.functional.pad(x, flat)
kernel_name = 'adaLN_cond__ssm_conv_h3__glu_gated_reglu__prompt'

def setup_inputs():

    _w = lambda a: (lambda t: t.to(torch.bfloat16) if t.is_floating_point() else t)(torch.as_tensor(a))

    def _A_setup():
        B, S, D = (1, 2048, 448)
        ks = 4
        return {'q': _w((lambda *s: torch.randn(*s, dtype=torch.bfloat16) * 0.05)(B, S, D)), 'k': _w((lambda *s: torch.randn(*s, dtype=torch.bfloat16) * 0.8)(B, S, D)), 'v': _w((lambda *s: torch.randn(*s, dtype=torch.bfloat16) * 0.8)(B, S, D)), 'shift_k': _w((lambda *s: torch.randn(*s, dtype=torch.bfloat16) * 0.8)(D, ks) * 0.5), 'ssm_k': _w((lambda *s: torch.randn(*s, dtype=torch.bfloat16) * 0.8)(D, S) * (1.0 / S ** 0.5)), 'ssm_D': _w((lambda *s: torch.randn(*s, dtype=torch.bfloat16) * 0.8)(D))}
    _A_in = _A_setup()

    def _B_setup():
        B, S, D, F = (1, 2048, 448, 1792)
        return {'x': _w((lambda *s: torch.randn(*s, dtype=torch.bfloat16) * 0.05)(B, S, D)), 'W_gate': _w((lambda *s: torch.randn(*s, dtype=torch.bfloat16) * 0.8)(D, F) * (2.0 / D) ** 0.5), 'W_up': _w((lambda *s: torch.randn(*s, dtype=torch.bfloat16) * 0.8)(D, F) * (2.0 / D) ** 0.5), 'W_down': _w((lambda *s: torch.randn(*s, dtype=torch.bfloat16) * 0.8)(F, D) * (1.0 / F) ** 0.5)}
    _B_in = _B_setup()
    return {'A_q': _A_in['q'], 'A_k': _A_in['k'], 'A_v': _A_in['v'], 'A_shift_k': _A_in['shift_k'], 'A_ssm_k': _A_in['ssm_k'], 'A_ssm_D': _A_in['ssm_D'], 'B_x': _B_in['x'], 'B_W_gate': _B_in['W_gate'], 'B_W_up': _B_in['W_up'], 'B_W_down': _B_in['W_down'], 'c': _w((lambda *s: torch.randn(*s, dtype=torch.bfloat16) * 0.2)(1, 448) * 8.0), 'w_mod': _w((lambda *s: torch.randn(*s, dtype=torch.bfloat16) * 0.2)(448, 6 * 448) * 448 ** (-0.5) * 8.0)}

def reference(A_q, A_k, A_v, A_shift_k, A_ssm_k, A_ssm_D, B_x, B_W_gate, B_W_up, B_W_down, c, w_mod):

    def _A_ref(q, k, v, shift_k, ssm_k, ssm_D):
        B, S, D = q.shape
        ks = shift_k.shape[-1]
        k_pad = _pad(k, ((0, 0), (ks - 1, 0), (0, 0)))
        k_shift = torch.zeros_like(k)
        for t in range(ks):
            k_shift = k_shift + k_pad[:, t:t + S, :] * shift_k[:, ks - 1 - t][None, None, :]
        kv = k_shift * v
        L = 2 * S
        kv_pad = _pad(kv, ((0, 0), (0, S), (0, 0)))
        kf_pad = _pad(ssm_k, ((0, 0), (0, S)))
        kv_f = (lambda x, axes=(-2, -1): torch.fft.rfft2(x.float(), dim=axes))(kv_pad[:, None, :, :], axes=(1, 2))
        kf_f = (lambda x, axes=(-2, -1): torch.fft.rfft2(x.float(), dim=axes))(kf_pad[:, None, :], axes=(1, 2))
        kf_f = (lambda x, *d: x.permute(*d))(kf_f, 1, 2, 0)
        y_f = kv_f * kf_f[None, :, :, :]
        y = (lambda x, s, axes=(-2, -1): torch.fft.irfft2(x, s=s, dim=axes).to(torch.bfloat16))(y_f, (1, L), axes=(1, 2))[:, 0, :S, :]
        y = y + kv * ssm_D[None, None, :]
        return q * y

    def _B_ref(x, W_gate, W_up, W_down):
        gate = torch.einsum('bsd,df->bsf', x, W_gate)
        up = torch.einsum('bsd,df->bsf', x, W_up)
        gate = gate * (lambda x, dt: x.to(dt))(gate > 0, gate.dtype)
        h = gate * up
        return torch.einsum('bsf,fd->bsd', h, W_down)
    x = A_q
    mod = (_silu(c) @ w_mod).reshape(c.shape[0], 6, 1, -1)
    sa, ca, ga, sb, cb, gb = (mod[:, 0].clone(), mod[:, 1].clone(), mod[:, 2].clone(), mod[:, 3].clone(), mod[:, 4].clone(), mod[:, 5].clone())
    h = _layernorm(x, axis=-1) * (1 + ca) + sa
    x = x + ga * _A_ref(h, A_k, A_v, A_shift_k, A_ssm_k, A_ssm_D)
    h = _layernorm(x, axis=-1) * (1 + cb) + sb
    x = x + gb * _B_ref(h, B_W_gate, B_W_up, B_W_down)
    return x
```

```asm
; @launch grid=(256,1,1) block=(256,1,1) lds=163840
.amdgcn_target "amdgcn-amd-amdhsa--gfx950"
.text
.p2align 12
.globl adaLN_cond__ssm_conv_h3__glu_gated_reglu__prompt_kernel
.p2align 8
.type adaLN_cond__ssm_conv_h3__glu_gated_reglu__prompt_kernel,@function
adaLN_cond__ssm_conv_h3__glu_gated_reglu__prompt_kernel:
    s_cmpk_ge_u32 s2, 256
    s_cbranch_scc1 L_exit
    s_load_dwordx2 s[4:5], s[0:1], 8
    s_load_dwordx2 s[16:17], s[0:1], 112
    s_load_dwordx2 s[8:9], s[0:1], 16
    s_getpc_b64 s[44:45]
    s_bfe_u32 s60, s2, 0x30003
    s_lshl_b32 s60, s60, 12
    v_lshl_add_u32 v1, v0, 4, s60
    v_min_u32 v1, L_end - L_pc - 4, v1
L_pc:
    global_load_dword v1, v1, s[44:45]
    v_lshrrev_b32 v2, 6, v0
    s_lshr_b32 s59, s2, 3
    v_readfirstlane_b32 s48, v2
    s_and_b32 s49, s2, 7
    s_mul_i32 s50, s59, 37
    s_lshr_b32 s50, s50, 8
    s_mul_i32 s51, s50, 7
    s_sub_u32 s51, s59, s51
    s_cmp_ge_u32 s59, 28
    s_cbranch_scc1 L_helper
    s_mov_b32 s6, 1835008
    s_mov_b32 s7, 0x20000
    s_mov_b64 s[10:11], s[6:7]
    s_lshl2_add_u32 s52, s49, s50
    s_lshl2_add_u32 s60, s52, s48
    s_mulk_i32 s60, 14336
    s_lshl_b32 s61, s51, 7
    s_add_u32 s60, s60, s61
    s_mul_i32 s80, s48, 14336
    v_bfe_u32 v4, v0, 3, 3
    v_and_b32 v2, 4, v4
    v_and_b32 v3, 7, v0
    v_xor_b32 v3, v3, v2
    v_mul_u32_u24 v232, 896, v4
    v_lshl_add_u32 v3, v3, 4, s60
    v_add_u32 v232, v232, v3
    s_movk_i32 s63, 7168
    s_add_u32 m0, s80, 1152
    s_waitcnt lgkmcnt(0)
    buffer_load_dwordx4 v232, s[4:7], 0 offen lds
    s_addk_i32 m0, 1152
    s_nop 0
    buffer_load_dwordx4 v232, s[4:7], s63 offen lds
    s_addk_i32 m0, 1152
    v_cmp_lt_u32 vcc, 4, v4
    buffer_load_dwordx4 v232, s[8:11], 0 offen lds
    s_addk_i32 m0, 1152
    v_subrev_u32 v233, s63, v232
    buffer_load_dwordx4 v232, s[8:11], s63 offen lds
    s_mov_b32 m0, s80
    v_cndmask_b32 v233, 2.0, v233, vcc
    buffer_load_dwordx4 v233, s[4:7], 0 offen lds
    s_load_dwordx2 s[20:21], s[0:1], 24
    s_mov_b32 s22, 3584
    s_mov_b32 s23, 0x20000
    s_load_dwordx2 s[72:73], s[0:1], 32
    s_mov_b32 s74, 1835008
    s_mov_b32 s75, 0x20000
    s_load_dwordx2 s[88:89], s[0:1], 40
    s_load_dwordx2 s[12:13], s[0:1], 0
    s_mov_b32 s14, 1835008
    s_mov_b32 s15, 0x20000
    s_mov_b32 s18, 11763712
    s_mov_b32 s19, 0x20000
    s_lshl_b32 s60, s49, 5
    s_add_u32 s59, s59, s60
    s_mov_b32 s56, 0xffff0000
    s_load_dwordx2 s[28:29], s[0:1], 56
    s_mov_b32 s30, 1605632
    s_mov_b32 s31, 0x20000
    s_load_dwordx2 s[32:33], s[0:1], 64
    s_mov_b32 s34, 1605632
    s_mov_b32 s35, 0x20000
    s_load_dwordx2 s[36:37], s[0:1], 72
    s_mov_b32 s38, 1605632
    s_mov_b32 s39, 0x20000
    s_load_dwordx2 s[40:41], s[0:1], 96
    s_mov_b32 s42, 1835008
    s_mov_b32 s43, 0x20000
    s_load_dwordx2 s[24:25], s[0:1], 88
    s_lshl_b32 s53, s51, 5
    s_add_u32 s53, s53, s52
    s_lshl_b32 s53, s53, 1
    v_bfe_u32 v234, v0, 2, 4
    s_lshl_b32 s61, s51, 9
    v_lshl_add_u32 v234, v234, 5, s61
    v_and_b32 v24, 63, v0
    v_lshlrev_b32 v24, 4, v24
    s_lshl_b32 s77, s53, 1
    s_add_u32 s62, s77, s48
    s_lshl_b32 s62, s62, 11
    v_add_u32 v236, s62, v24
    s_and_b32 s63, s48, 1
    s_lshl_b32 s63, s63, 2
    s_sub_u32 s79, s62, s63
    v_lshrrev_b32 v235, 5, v0
    s_lshl_b32 s60, s59, 3
    v_add_u32 v235, s60, v235
    v_mul_u32_u24 v235, 896, v235
    v_and_b32 v84, 31, v0
    v_lshl_add_u32 v235, v84, 4, v235
    v_cmp_gt_u32 vcc, 28, v84
    v_mov_b32 v84, 2147483392
    s_nop 0
    v_cndmask_b32 v235, v84, v235, vcc
    v_bfe_u32 v22, v0, 2, 4
    v_min_u32 v22, 3, v22
    s_and_b32 s60, s49, 6
    s_mul_i32 s60, s60, 3
    s_add_u32 s60, s60, s49
    v_lshl_add_u32 v22, v22, 1, s60
    v_subrev_u32 v23, 21, v22
    v_cmp_gt_u32 vcc, 7, v23
    s_nop 1
    v_cndmask_b32 v25, 0, 14, vcc
    v_cmp_gt_u32 vcc, 14, v23
    s_nop 1
    v_cndmask_b32 v23, 0, -7, vcc
    v_add3_u32 v22, v22, v23, v25
    v_and_b32 v23, 3, v0
    s_lshr_b32 s60, s2, 3
    s_lshl_b32 s60, s60, 2
    s_add_u32 s60, s60, s48
    s_mul_i32 s60, s60, 21504
    v_mul_u32_u24 v23, 5376, v23
    v_lshl_add_u32 v22, v22, 7, v23
    v_add_u32 v22, s60, v22
    s_waitcnt lgkmcnt(0)
    s_mov_b64 s[8:9], s[24:25]
    s_mov_b32 s10, 2408448
    s_load_dwordx2 s[46:47], s[16:17], 0
    s_load_dword s58, s[88:89], s77
    s_load_dword s76, s[72:73], s79
    buffer_load_dwordx4 v[56:59], v234, s[20:23], 0 offen
    buffer_load_dwordx4 v[60:63], v234, s[20:23], 0 offen offset:16
    buffer_load_dwordx4 v[72:75], v236, s[72:75], 0 offen
    buffer_load_dwordx4 v[76:79], v236, s[72:75], 0 offen offset:1024
    s_lshl_b32 s61, s48, 12
    v_add_u32 v9, s61, v24
    v_bfe_u32 v2, v0, 2, 4
    v_and_b32 v3, 3, v0
    v_mul_u32_u24 v31, 33792, v2
    v_lshl_add_u32 v31, v3, 4, v31
    v_mul_u32_u24 v10, 3584, v2
    v_lshl_add_u32 v10, v3, 4, v10
    v_mul_u32_u24 v240, 4256, v3
    v_min_u32 v4, 4, v2
    v_lshl_add_u32 v240, v4, 4, v240
    v_add_u32 v240, 140288, v240
    v_lshlrev_b32 v2, 3, v2
    v_add_u32 v4, 2, v3
    v_and_b32 v5, 1, v4
    v_lshrrev_b32 v4, 1, v4
    v_mul_u32_u24 v5, 576, v5
    v_mul_u32_u24 v4, 1152, v4
    v_xor_b32 v5, v5, v2
    v_add3_u32 v237, v4, v5, s80
    v_add_u32 v4, 1, v3
    v_and_b32 v5, 1, v4
    v_lshrrev_b32 v4, 1, v4
    v_mul_u32_u24 v5, 576, v5
    v_mul_u32_u24 v4, 1152, v4
    v_xor_b32 v5, v5, v2
    v_add3_u32 v238, v4, v5, s80
    s_mul_i32 s60, s51, 540672
    s_lshl_b32 s61, s52, 8
    s_lshl_b32 s62, s48, 6
    s_add_u32 s61, s61, s62
    s_add_u32 s60, s60, s61
    s_add_u32 s64, s60, 393216
    s_add_u32 s65, s60, 401408
    s_add_u32 s66, s60, 410112
    s_add_u32 s67, s60, 418304
    s_lshr_b32 s60, s48, 1
    s_mul_i32 s60, s60, 4416
    s_lshl_b32 s61, s48, 11
    s_add_u32 s60, s60, s61
    s_add_u32 s60, s60, 140368
    v_add_u32 v239, s60, v24
    v_and_b32 v3, 1, v0
    v_mul_u32_u24 v241, 4608, v3
    v_bfe_u32 v2, v0, 1, 5
    v_lshl_add_u32 v241, v2, 4, v241
    v_add_u32 v241, 118784, v241
    v_mov_b32 v96, 0
    v_mov_b32 v97, 0
    v_mov_b32 v98, 0
    v_mov_b32 v99, 0
    v_and_b32 v8, 3, v0
    v_and_b32 v2, v2, v3
    v_add_u32 v8, v8, v2
    v_mul_u32_u24 v8, 1792, v8
    v_mul_u32_u24 v3, 4256, v3
    v_and_b32 v2, 7, v0
    v_or_b32 v2, 1, v2
    v_bfe_u32 v4, v0, 3, 1
    v_lshl_add_u32 v2, v4, 5, v2
    v_bfe_u32 v25, v0, 4, 2
    v_lshl_add_u32 v2, v25, 3, v2
    v_lshlrev_b32 v2, 1, v2
    v_sub_u32 v2, v2, v3
    s_and_b32 s63, s48, 1
    s_lshr_b32 s62, s48, 1
    s_mul_i32 s60, s62, 8512
    s_lshl_b32 s61, s63, 8
    s_add_u32 s60, s60, s61
    s_add_u32 s60, s60, 144546
    v_add_u32 v2, s60, v2
    s_waitcnt lgkmcnt(0)
    s_lshl_b32 s60, s62, 4
    s_lshr_b32 s58, s58, s60
    s_lshl_b32 s58, s58, 16
    s_mul_i32 s76, s76, s63
    v_mov_b32 v80, s76
    v_and_b32 v82, 127, v0
    v_cmp_eq_u32 vcc, 0, v82
    v_mov_b32 v82, s58
    s_nop 0
    v_cndmask_b32 v82, 0, v82, vcc
    ds_write_b128 v240, v[96:99]
    ds_write_b128 v241, v[96:99]
    s_add_u32 s46, s46, 0x7f4a7c15
    s_addc_u32 s47, s47, 0x9e3779b9
    v_mov_b32 v14, s46
    v_mov_b32 v15, s47
    v_lshrrev_b32 v27, 2, v0
    v_lshlrev_b32 v27, 25, v27
    v_and_or_b32 v27, v24, 63, v27
    s_lshl_b32 s59, s59, 6
    s_add_u32 s59, s59, 4096
    s_lshl_b32 s60, s49, 7
    s_cmp_ge_u32 s2, 8
    s_cbranch_scc1 L_nogo
    s_cmp_lg_u32 s48, 0
    s_cbranch_scc1 noflag_1
    buffer_store_dwordx4 v[12:15], v27, s[16:19], s60 offen offset:2048 sc1
noflag_1:
L_nogo:
    s_add_u32 m0, s80, 5760
    s_movk_i32 s60, 7168
    buffer_load_dwordx4 v232, s[12:15], 0 offen lds
    s_add_u32 m0, s80, 6912
    s_nop 0
    buffer_load_dwordx4 v232, s[12:15], s60 offen lds
    buffer_load_dwordx4 v[84:87], v235, s[12:15], 0 offen
    buffer_load_dwordx4 v[88:91], v235, s[12:15], 0 offen offset:448
    buffer_load_dword v1, v22, s[8:11], 0 offen
    s_lshl_b32 s60, s2, 7
    v_mov_b32 v23, s60
    buffer_load_dword v1, v23, s[16:19], 0 offen
    s_lshl2_add_u32 s60, s2, s48
    s_mulk_i32 s60, 384
    s_add_u32 s60, s60, 0x8000
    v_bfe_u32 v22, v0, 4, 2
    v_min_u32 v22, 2, v22
    v_lshl_add_u32 v22, v22, 7, s60
    buffer_load_dword v1, v22, s[16:19], 0 offen
    s_lshr_b32 s60, s48, 1
    s_lshl1_add_u32 s60, s2, s60
    s_mulk_i32 s60, 5376
    s_and_b32 s61, s48, 1
    v_bfe_u32 v22, v0, 4, 2
    v_min_u32 v22, 1, v22
    s_mul_i32 s61, s61, 2
    v_add_u32 v22, s61, v22
    v_cmp_eq_u32 vcc, 3, v22
    s_nop 1
    v_cndmask_b32 v22, v22, 10, vcc
    s_addk_i32 s60, 3200
    v_lshlrev_b32 v22, 7, v22
    buffer_load_dword v1, v22, s[8:11], s60 offen
    s_waitcnt vmcnt(10)
    ds_read_b64 v[32:33], v238 offset:128
    ds_read_b64 v[34:35], v238 offset:256
    ds_read_b64 v[36:37], v238 offset:384
    ds_read_b64 v[38:39], v237 offset:0
    ds_read_b64 v[40:41], v237 offset:128
    ds_read_b64 v[42:43], v237 offset:256
    ds_read_b64 v[44:45], v237 offset:384
    v_lshlrev_b32 v96, 16, v56
    v_and_b32 v100, s56, v56
    v_lshlrev_b32 v104, 16, v57
    v_and_b32 v108, s56, v57
    v_lshlrev_b32 v97, 16, v58
    v_and_b32 v101, s56, v58
    v_lshlrev_b32 v105, 16, v59
    v_and_b32 v109, s56, v59
    v_lshlrev_b32 v98, 16, v60
    v_and_b32 v102, s56, v60
    v_lshlrev_b32 v106, 16, v61
    v_and_b32 v110, s56, v61
    v_lshlrev_b32 v99, 16, v62
    v_and_b32 v103, s56, v62
    v_lshlrev_b32 v107, 16, v63
    v_and_b32 v111, s56, v63
    v_mov_b32 v204, 0x47800080
    v_mov_b32 v205, 0xc7800000
    v_pk_mul_f32 v[144:145], v[96:97], v[204:205] op_sel_hi:[1,0]
    v_pk_mul_f32 v[160:161], v[96:97], v[204:205] op_sel:[0,1]
    v_pk_mul_f32 v[146:147], v[98:99], v[204:205] op_sel_hi:[1,0]
    v_pk_mul_f32 v[162:163], v[98:99], v[204:205] op_sel:[0,1]
    v_pk_mul_f32 v[148:149], v[100:101], v[204:205] op_sel_hi:[1,0]
    v_pk_mul_f32 v[164:165], v[100:101], v[204:205] op_sel:[0,1]
    v_pk_mul_f32 v[150:151], v[102:103], v[204:205] op_sel_hi:[1,0]
    v_pk_mul_f32 v[166:167], v[102:103], v[204:205] op_sel:[0,1]
    v_pk_mul_f32 v[152:153], v[104:105], v[204:205] op_sel_hi:[1,0]
    v_pk_mul_f32 v[168:169], v[104:105], v[204:205] op_sel:[0,1]
    v_pk_mul_f32 v[154:155], v[106:107], v[204:205] op_sel_hi:[1,0]
    v_pk_mul_f32 v[170:171], v[106:107], v[204:205] op_sel:[0,1]
    v_pk_mul_f32 v[156:157], v[108:109], v[204:205] op_sel_hi:[1,0]
    v_pk_mul_f32 v[172:173], v[108:109], v[204:205] op_sel:[0,1]
    v_pk_mul_f32 v[158:159], v[110:111], v[204:205] op_sel_hi:[1,0]
    v_pk_mul_f32 v[174:175], v[110:111], v[204:205] op_sel:[0,1]
    s_waitcnt lgkmcnt(6)
    v_lshlrev_b32 v176, 16, v32
    v_and_b32 v177, s56, v32
    v_lshlrev_b32 v178, 16, v33
    v_and_b32 v179, s56, v33
    s_waitcnt lgkmcnt(5)
    v_lshlrev_b32 v180, 16, v34
    v_and_b32 v181, s56, v34
    v_lshlrev_b32 v182, 16, v35
    v_and_b32 v183, s56, v35
    s_waitcnt lgkmcnt(4)
    v_lshlrev_b32 v184, 16, v36
    v_and_b32 v185, s56, v36
    v_lshlrev_b32 v186, 16, v37
    v_and_b32 v187, s56, v37
    s_waitcnt lgkmcnt(3)
    v_lshlrev_b32 v188, 16, v38
    v_and_b32 v189, s56, v38
    v_lshlrev_b32 v190, 16, v39
    v_and_b32 v191, s56, v39
    s_waitcnt lgkmcnt(2)
    v_lshlrev_b32 v192, 16, v40
    v_and_b32 v193, s56, v40
    v_lshlrev_b32 v194, 16, v41
    v_and_b32 v195, s56, v41
    s_waitcnt lgkmcnt(1)
    v_lshlrev_b32 v196, 16, v42
    v_and_b32 v197, s56, v42
    v_lshlrev_b32 v198, 16, v43
    v_and_b32 v199, s56, v43
    s_waitcnt lgkmcnt(0)
    v_lshlrev_b32 v200, 16, v44
    v_and_b32 v201, s56, v44
    v_lshlrev_b32 v202, 16, v45
    v_and_b32 v203, s56, v45
    v_pk_mul_f32 v[224:225], v[176:177], v[156:157]
    v_pk_mul_f32 v[226:227], v[180:181], v[156:157]
    v_pk_mul_f32 v[228:229], v[184:185], v[156:157]
    v_pk_mul_f32 v[230:231], v[188:189], v[156:157]
    v_pk_fma_f32 v[112:113], v[176:177], v[172:173], v[224:225]
    v_pk_fma_f32 v[116:117], v[180:181], v[172:173], v[226:227]
    v_pk_fma_f32 v[120:121], v[184:185], v[172:173], v[228:229]
    v_pk_fma_f32 v[124:125], v[188:189], v[172:173], v[230:231]
    v_pk_mul_f32 v[224:225], v[178:179], v[158:159]
    v_pk_mul_f32 v[226:227], v[182:183], v[158:159]
    v_pk_mul_f32 v[228:229], v[186:187], v[158:159]
    v_pk_mul_f32 v[230:231], v[190:191], v[158:159]
    v_pk_fma_f32 v[114:115], v[178:179], v[174:175], v[224:225]
    v_pk_fma_f32 v[118:119], v[182:183], v[174:175], v[226:227]
    v_pk_fma_f32 v[122:123], v[186:187], v[174:175], v[228:229]
    v_pk_fma_f32 v[126:127], v[190:191], v[174:175], v[230:231]
    v_pk_mul_f32 v[224:225], v[180:181], v[152:153]
    v_pk_mul_f32 v[226:227], v[184:185], v[152:153]
    v_pk_mul_f32 v[228:229], v[188:189], v[152:153]
    v_pk_mul_f32 v[230:231], v[192:193], v[152:153]
    v_pk_fma_f32 v[224:225], v[180:181], v[168:169], v[224:225]
    v_pk_fma_f32 v[226:227], v[184:185], v[168:169], v[226:227]
    v_pk_fma_f32 v[228:229], v[188:189], v[168:169], v[228:229]
    v_pk_fma_f32 v[230:231], v[192:193], v[168:169], v[230:231]
    v_pk_add_f32 v[112:113], v[112:113], v[224:225]
    v_pk_add_f32 v[116:117], v[116:117], v[226:227]
    v_pk_add_f32 v[120:121], v[120:121], v[228:229]
    v_pk_add_f32 v[124:125], v[124:125], v[230:231]
    v_pk_mul_f32 v[224:225], v[112:113], v[204:205] op_sel_hi:[1,0]
    v_pk_mul_f32 v[226:227], v[116:117], v[204:205] op_sel_hi:[1,0]
    v_pk_mul_f32 v[228:229], v[120:121], v[204:205] op_sel_hi:[1,0]
    v_pk_mul_f32 v[230:231], v[124:125], v[204:205] op_sel_hi:[1,0]
    v_pk_fma_f32 v[112:113], v[112:113], v[204:205], v[224:225] op_sel:[0,1,0]
    v_pk_fma_f32 v[116:117], v[116:117], v[204:205], v[226:227] op_sel:[0,1,0]
    v_pk_fma_f32 v[120:121], v[120:121], v[204:205], v[228:229] op_sel:[0,1,0]
    v_pk_fma_f32 v[124:125], v[124:125], v[204:205], v[230:231] op_sel:[0,1,0]
    v_pk_mul_f32 v[224:225], v[182:183], v[154:155]
    v_pk_mul_f32 v[226:227], v[186:187], v[154:155]
    v_pk_mul_f32 v[228:229], v[190:191], v[154:155]
    v_pk_mul_f32 v[230:231], v[194:195], v[154:155]
    v_pk_fma_f32 v[224:225], v[182:183], v[170:171], v[224:225]
    v_pk_fma_f32 v[226:227], v[186:187], v[170:171], v[226:227]
    v_pk_fma_f32 v[228:229], v[190:191], v[170:171], v[228:229]
    v_pk_fma_f32 v[230:231], v[194:195], v[170:171], v[230:231]
    v_pk_add_f32 v[114:115], v[114:115], v[224:225]
    v_pk_add_f32 v[118:119], v[118:119], v[226:227]
    v_pk_add_f32 v[122:123], v[122:123], v[228:229]
    v_pk_add_f32 v[126:127], v[126:127], v[230:231]
    v_pk_mul_f32 v[224:225], v[114:115], v[204:205] op_sel_hi:[1,0]
    v_pk_mul_f32 v[226:227], v[118:119], v[204:205] op_sel_hi:[1,0]
    v_pk_mul_f32 v[228:229], v[122:123], v[204:205] op_sel_hi:[1,0]
    v_pk_mul_f32 v[230:231], v[126:127], v[204:205] op_sel_hi:[1,0]
    v_pk_fma_f32 v[114:115], v[114:115], v[204:205], v[224:225] op_sel:[0,1,0]
    v_pk_fma_f32 v[118:119], v[118:119], v[204:205], v[226:227] op_sel:[0,1,0]
    v_pk_fma_f32 v[122:123], v[122:123], v[204:205], v[228:229] op_sel:[0,1,0]
    v_pk_fma_f32 v[126:127], v[126:127], v[204:205], v[230:231] op_sel:[0,1,0]
    ds_read_b64 v[46:47], v237 offset:2304
    ds_read_b64 v[48:49], v237 offset:2432
    ds_read_b64 v[50:51], v237 offset:2560
    ds_read_b64 v[52:53], v237 offset:2688
    v_pk_mul_f32 v[224:225], v[184:185], v[148:149]
    v_pk_mul_f32 v[226:227], v[188:189], v[148:149]
    v_pk_mul_f32 v[228:229], v[192:193], v[148:149]
    v_pk_mul_f32 v[230:231], v[196:197], v[148:149]
    v_pk_fma_f32 v[224:225], v[184:185], v[164:165], v[224:225]
    v_pk_fma_f32 v[226:227], v[188:189], v[164:165], v[226:227]
    v_pk_fma_f32 v[228:229], v[192:193], v[164:165], v[228:229]
    v_pk_fma_f32 v[230:231], v[196:197], v[164:165], v[230:231]
    v_pk_add_f32 v[112:113], v[112:113], v[224:225]
    v_pk_add_f32 v[116:117], v[116:117], v[226:227]
    v_pk_add_f32 v[120:121], v[120:121], v[228:229]
    v_pk_add_f32 v[124:125], v[124:125], v[230:231]
    v_pk_mul_f32 v[224:225], v[112:113], v[204:205] op_sel_hi:[1,0]
    v_pk_mul_f32 v[226:227], v[116:117], v[204:205] op_sel_hi:[1,0]
    v_pk_mul_f32 v[228:229], v[120:121], v[204:205] op_sel_hi:[1,0]
    v_pk_mul_f32 v[230:231], v[124:125], v[204:205] op_sel_hi:[1,0]
    v_pk_fma_f32 v[112:113], v[112:113], v[204:205], v[224:225] op_sel:[0,1,0]
    v_pk_fma_f32 v[116:117], v[116:117], v[204:205], v[226:227] op_sel:[0,1,0]
    v_pk_fma_f32 v[120:121], v[120:121], v[204:205], v[228:229] op_sel:[0,1,0]
    v_pk_fma_f32 v[124:125], v[124:125], v[204:205], v[230:231] op_sel:[0,1,0]
    v_pk_mul_f32 v[224:225], v[186:187], v[150:151]
    v_pk_mul_f32 v[226:227], v[190:191], v[150:151]
    v_pk_mul_f32 v[228:229], v[194:195], v[150:151]
    v_pk_mul_f32 v[230:231], v[198:199], v[150:151]
    v_pk_fma_f32 v[224:225], v[186:187], v[166:167], v[224:225]
    v_pk_fma_f32 v[226:227], v[190:191], v[166:167], v[226:227]
    v_pk_fma_f32 v[228:229], v[194:195], v[166:167], v[228:229]
    v_pk_fma_f32 v[230:231], v[198:199], v[166:167], v[230:231]
    v_pk_add_f32 v[114:115], v[114:115], v[224:225]
    v_pk_add_f32 v[118:119], v[118:119], v[226:227]
    v_pk_add_f32 v[122:123], v[122:123], v[228:229]
    v_pk_add_f32 v[126:127], v[126:127], v[230:231]
    v_pk_mul_f32 v[224:225], v[114:115], v[204:205] op_sel_hi:[1,0]
    v_pk_mul_f32 v[226:227], v[118:119], v[204:205] op_sel_hi:[1,0]
    v_pk_mul_f32 v[228:229], v[122:123], v[204:205] op_sel_hi:[1,0]
    v_pk_mul_f32 v[230:231], v[126:127], v[204:205] op_sel_hi:[1,0]
    v_pk_fma_f32 v[114:115], v[114:115], v[204:205], v[224:225] op_sel:[0,1,0]
    v_pk_fma_f32 v[118:119], v[118:119], v[204:205], v[226:227] op_sel:[0,1,0]
    v_pk_fma_f32 v[122:123], v[122:123], v[204:205], v[228:229] op_sel:[0,1,0]
    v_pk_fma_f32 v[126:127], v[126:127], v[204:205], v[230:231] op_sel:[0,1,0]
    v_pk_mul_f32 v[224:225], v[188:189], v[144:145]
    v_pk_mul_f32 v[226:227], v[192:193], v[144:145]
    v_pk_mul_f32 v[228:229], v[196:197], v[144:145]
    v_pk_mul_f32 v[230:231], v[200:201], v[144:145]
    v_pk_fma_f32 v[224:225], v[188:189], v[160:161], v[224:225]
    v_pk_fma_f32 v[226:227], v[192:193], v[160:161], v[226:227]
    v_pk_fma_f32 v[228:229], v[196:197], v[160:161], v[228:229]
    v_pk_fma_f32 v[230:231], v[200:201], v[160:161], v[230:231]
    v_pk_add_f32 v[112:113], v[112:113], v[224:225]
    v_pk_add_f32 v[116:117], v[116:117], v[226:227]
    v_pk_add_f32 v[120:121], v[120:121], v[228:229]
    v_pk_add_f32 v[124:125], v[124:125], v[230:231]
    v_pk_mul_f32 v[224:225], v[112:113], v[204:205] op_sel_hi:[1,0]
    v_pk_mul_f32 v[226:227], v[116:117], v[204:205] op_sel_hi:[1,0]
    v_pk_mul_f32 v[228:229], v[120:121], v[204:205] op_sel_hi:[1,0]
    v_pk_mul_f32 v[230:231], v[124:125], v[204:205] op_sel_hi:[1,0]
    v_pk_fma_f32 v[112:113], v[112:113], v[204:205], v[224:225] op_sel:[0,1,0]
    v_pk_fma_f32 v[116:117], v[116:117], v[204:205], v[226:227] op_sel:[0,1,0]
    v_pk_fma_f32 v[120:121], v[120:121], v[204:205], v[228:229] op_sel:[0,1,0]
    v_pk_fma_f32 v[124:125], v[124:125], v[204:205], v[230:231] op_sel:[0,1,0]
    v_pk_mul_f32 v[224:225], v[190:191], v[146:147]
    v_pk_mul_f32 v[226:227], v[194:195], v[146:147]
    v_pk_mul_f32 v[228:229], v[198:199], v[146:147]
    v_pk_mul_f32 v[230:231], v[202:203], v[146:147]
    v_pk_fma_f32 v[224:225], v[190:191], v[162:163], v[224:225]
    v_pk_fma_f32 v[226:227], v[194:195], v[162:163], v[226:227]
    v_pk_fma_f32 v[228:229], v[198:199], v[162:163], v[228:229]
    v_pk_fma_f32 v[230:231], v[202:203], v[162:163], v[230:231]
    v_pk_add_f32 v[114:115], v[114:115], v[224:225]
    v_pk_add_f32 v[118:119], v[118:119], v[226:227]
    v_pk_add_f32 v[122:123], v[122:123], v[228:229]
    v_pk_add_f32 v[126:127], v[126:127], v[230:231]
    v_pk_mul_f32 v[224:225], v[114:115], v[204:205] op_sel_hi:[1,0]
    v_pk_mul_f32 v[226:227], v[118:119], v[204:205] op_sel_hi:[1,0]
    v_pk_mul_f32 v[228:229], v[122:123], v[204:205] op_sel_hi:[1,0]
    v_pk_mul_f32 v[230:231], v[126:127], v[204:205] op_sel_hi:[1,0]
    v_pk_fma_f32 v[114:115], v[114:115], v[204:205], v[224:225] op_sel:[0,1,0]
    v_pk_fma_f32 v[118:119], v[118:119], v[204:205], v[226:227] op_sel:[0,1,0]
    v_pk_fma_f32 v[122:123], v[122:123], v[204:205], v[228:229] op_sel:[0,1,0]
    v_pk_fma_f32 v[126:127], v[126:127], v[204:205], v[230:231] op_sel:[0,1,0]
    s_waitcnt lgkmcnt(0)
    v_lshlrev_b32 v208, 16, v46
    v_and_b32 v209, s56, v46
    v_pk_mul_f32 v[112:113], v[112:113], v[208:209]
    v_lshlrev_b32 v212, 16, v48
    v_and_b32 v213, s56, v48
    v_pk_mul_f32 v[116:117], v[116:117], v[212:213]
    v_lshlrev_b32 v216, 16, v50
    v_and_b32 v217, s56, v50
    v_pk_mul_f32 v[120:121], v[120:121], v[216:217]
    v_lshlrev_b32 v220, 16, v52
    v_and_b32 v221, s56, v52
    v_pk_mul_f32 v[124:125], v[124:125], v[220:221]
    v_cvt_pk_bf16_f32 v128, v124, v120
    v_cvt_pk_bf16_f32 v129, v116, v112
    v_cvt_pk_bf16_f32 v132, v125, v121
    v_cvt_pk_bf16_f32 v133, v117, v113
    v_lshlrev_b32 v210, 16, v47
    v_and_b32 v211, s56, v47
    v_pk_mul_f32 v[114:115], v[114:115], v[210:211]
    v_lshlrev_b32 v214, 16, v49
    v_and_b32 v215, s56, v49
    v_pk_mul_f32 v[118:119], v[118:119], v[214:215]
    v_lshlrev_b32 v218, 16, v51
    v_and_b32 v219, s56, v51
    v_pk_mul_f32 v[122:123], v[122:123], v[218:219]
    v_lshlrev_b32 v222, 16, v53
    v_and_b32 v223, s56, v53
    v_pk_mul_f32 v[126:127], v[126:127], v[222:223]
    v_cvt_pk_bf16_f32 v136, v126, v122
    v_cvt_pk_bf16_f32 v137, v118, v114
    v_cvt_pk_bf16_f32 v140, v127, v123
    v_cvt_pk_bf16_f32 v141, v119, v115
    s_waitcnt vmcnt(8)
    v_readlane_b32 s76, v75, 63
    v_lshlrev_b32 v83, 16, v72
    v_and_b32 v72, s56, v72
    v_add_f32 v83, v83, v82
    v_cvt_pk_bf16_f32 v72, v83, v72
    ds_write_b128 v239, v[72:75]
    ds_write_b128 v239, v[76:79] offset:1024
    v_mov_b32 v81, s76
    v_alignbit_b32 v97, v73, v72, 16
    v_alignbit_b32 v98, v74, v73, 16
    v_alignbit_b32 v99, v75, v74, 16
    v_mov_b32_dpp v80, v75 wave_shr:1 row_mask:0xf bank_mask:0xf
    v_alignbit_b32 v96, v72, v80, 16
    ds_write_b128 v239, v[96:99] offset:4256
    v_alignbit_b32 v101, v77, v76, 16
    v_alignbit_b32 v102, v78, v77, 16
    v_alignbit_b32 v103, v79, v78, 16
    v_mov_b32_dpp v81, v79 wave_shr:1 row_mask:0xf bank_mask:0xf
    v_alignbit_b32 v100, v76, v81, 16
    ds_write_b128 v239, v[100:103] offset:5280
    s_mov_b32 s60, 0x05040100
    s_mov_b32 s61, 0x07060302
    v_and_b32 v23, 7, v0
    v_lshlrev_b32 v23, 7, v23
    s_waitcnt vmcnt(4)
    s_cmp_lg_u32 s48, 0
    s_cbranch_scc1 L_nogo1
    buffer_load_dwordx4 v[56:59], v23, s[16:19], 0 offen offset:2048 sc1
L_nogo1:
    ds_read_b64 v[64:65], v237 offset:4608
    ds_read_b64 v[66:67], v237 offset:4736
    ds_read_b64 v[68:69], v237 offset:4864
    ds_read_b64 v[70:71], v237 offset:4992
    s_waitcnt lgkmcnt(0)
    v_perm_b32 v130, v66, v64, s60
    v_perm_b32 v131, v70, v68, s60
    v_perm_b32 v134, v66, v64, s61
    v_perm_b32 v135, v70, v68, s61
    v_perm_b32 v138, v67, v65, s60
    v_perm_b32 v139, v71, v69, s60
    v_perm_b32 v142, v67, v65, s61
    v_perm_b32 v143, v71, v69, s61
    s_mov_b32 s61, 0x3f803f80
    v_mov_b32 v92, 0
    v_mov_b32 v93, 0
    v_dot2c_f32_bf16 v92, s61, v84
    v_dot2c_f32_bf16 v93, v84, v84
    v_dot2c_f32_bf16 v92, s61, v85
    v_dot2c_f32_bf16 v93, v85, v85
    v_dot2c_f32_bf16 v92, s61, v86
    v_dot2c_f32_bf16 v93, v86, v86
    v_dot2c_f32_bf16 v92, s61, v87
    v_dot2c_f32_bf16 v93, v87, v87
    v_dot2c_f32_bf16 v92, s61, v88
    v_dot2c_f32_bf16 v93, v88, v88
    v_dot2c_f32_bf16 v92, s61, v89
    v_dot2c_f32_bf16 v93, v89, v89
    v_dot2c_f32_bf16 v92, s61, v90
    v_dot2c_f32_bf16 v93, v90, v90
    v_dot2c_f32_bf16 v92, s61, v91
    v_dot2c_f32_bf16 v93, v91, v91
    s_nop 1
    v_add_f32_dpp v92, v92, v92 quad_perm:[1,0,3,2] row_mask:0xf bank_mask:0xf
    v_add_f32_dpp v93, v93, v93 quad_perm:[1,0,3,2] row_mask:0xf bank_mask:0xf
    s_nop 0
    v_add_f32_dpp v92, v92, v92 quad_perm:[2,3,0,1] row_mask:0xf bank_mask:0xf
    v_add_f32_dpp v93, v93, v93 quad_perm:[2,3,0,1] row_mask:0xf bank_mask:0xf
    s_nop 0
    v_add_f32_dpp v92, v92, v92 row_half_mirror row_mask:0xf bank_mask:0xf
    v_add_f32_dpp v93, v93, v93 row_half_mirror row_mask:0xf bank_mask:0xf
    s_nop 0
    v_add_f32_dpp v92, v92, v92 row_mirror row_mask:0xf bank_mask:0xf
    v_add_f32_dpp v93, v93, v93 row_mirror row_mask:0xf bank_mask:0xf
    v_mov_b32 v84, v92
    v_mov_b32 v85, v93
    s_nop 0
    v_permlane16_swap_b32 v92, v84
    v_permlane16_swap_b32 v93, v85
    v_add_f32 v92, v92, v84
    v_add_f32 v93, v93, v85
    v_mul_f32 v92, 0x3b124925, v92
    v_mul_f32 v93, 0x3b124925, v93
    v_fma_f32 v93, -v92, v92, v93
    v_max_f32 v93, 0, v93
    v_cvt_pk_bf16_f32 v93, v93, v93
    v_lshlrev_b32 v93, 16, v93
    v_add_f32 v93, 0x3727c5ac, v93
    v_cvt_pk_bf16_f32 v93, v93, v93
    v_lshlrev_b32 v93, 16, v93
    v_sqrt_f32 v93, v93
    s_nop 0
    v_cvt_pk_bf16_f32 v92, v92, v93
    v_lshrrev_b32 v93, 5, v0
    v_lshlrev_b32 v93, 2, v93
    v_add_u32 v93, 159360, v93
    ds_write_b32 v93, v92
    v_and_b32 v84, 3, v0
    v_lshlrev_b32 v84, 3, v84
    v_add_u32 v84, 159360, v84
    s_waitcnt vmcnt(0) lgkmcnt(0)
    s_cmp_lg_u32 s48, 0
    s_cbranch_scc1 L_nogo2
    v_cmp_ne_u64 vcc, s[46:47], v[58:59]
    s_cbranch_vccnz retry_2
back_3:
L_nogo2:
    s_barrier
    buffer_store_dwordx4 v[128:131], v31, s[16:19], s64 offen sc1
    buffer_store_dwordx4 v[132:135], v31, s[16:19], s65 offen sc1
    buffer_store_dwordx4 v[136:139], v31, s[16:19], s66 offen sc1
    buffer_store_dwordx4 v[140:143], v31, s[16:19], s67 offen sc1
    ds_read_b64 v[12:13], v84
    ds_read2_b32 v[160:161], v2 offset0:0 offset1:1
    ds_read2_b32 v[162:163], v2 offset0:2 offset1:3
    s_lshr_b32 s54, s49, 1
    s_lshl_b32 s54, s54, 2
    s_add_u32 s54, s54, s50
    s_and_b32 s55, s49, 1
    ds_read2_b32 v[192:193], v2 offset0:16 offset1:17
    ds_read2_b32 v[194:195], v2 offset0:18 offset1:19
    s_mul_i32 s55, s55, 7
    s_add_u32 s55, s55, s51
    s_lshl_b32 s60, s55, 8
    ds_read2_b32 v[224:225], v2 offset0:32 offset1:33
    ds_read2_b32 v[226:227], v2 offset0:34 offset1:35
    s_lshl_b32 s61, s48, 6
    s_add_u32 s60, s60, s61
    v_add_u32 v10, s60, v10
    ds_read2_b32 a[224:225], v2 offset0:48 offset1:49
    ds_read2_b32 a[226:227], v2 offset0:50 offset1:51
    v_bfe_u32 v19, v0, 2, 3
    v_mul_u32_u24 v19, 896, v19
    v_bfe_u32 v23, v0, 5, 1
    ds_read2_b32 v[164:165], v2 offset0:128 offset1:129
    ds_read2_b32 v[166:167], v2 offset0:130 offset1:131
    v_lshl_add_u32 v19, v23, 6, v19
    v_and_b32 v23, 3, v0
    v_lshl_add_u32 v19, v23, 4, v19
    s_lshr_b32 s60, s48, 1
    ds_read2_b32 v[196:197], v2 offset0:144 offset1:145
    ds_read2_b32 v[198:199], v2 offset0:146 offset1:147
    s_mul_i32 s60, s60, 802816
    s_and_b32 s61, s48, 1
    s_mul_i32 s61, s61, 57344
    ds_read2_b32 v[228:229], v2 offset0:160 offset1:161
    ds_read2_b32 v[230:231], v2 offset0:162 offset1:163
    s_add_u32 s60, s60, s61
    s_lshl_b32 s61, s51, 7
    s_add_u32 s60, s60, s61
    ds_read2_b32 a[228:229], v2 offset0:176 offset1:177
    ds_read2_b32 a[230:231], v2 offset0:178 offset1:179
    v_add_u32 v2, 1024, v2
    v_add_u32 v19, s60, v19
    s_mul_i32 s81, s48, 10240
    s_add_u32 s81, s81, 114688
    ds_read2_b32 v[168:169], v2 offset0:0 offset1:1
    ds_read2_b32 v[170:171], v2 offset0:2 offset1:3
    s_mov_b32 s82, 56320
    s_mov_b32 s85, 13312
    s_mov_b32 s83, 112640
    ds_read2_b32 v[200:201], v2 offset0:16 offset1:17
    ds_read2_b32 v[202:203], v2 offset0:18 offset1:19
    s_mov_b32 s86, 5120
    s_mov_b32 s84, 168960
    s_mov_b32 s87, 18432
    v_bfe_u32 v11, v0, 2, 2
    ds_read2_b32 v[232:233], v2 offset0:32 offset1:33
    ds_read2_b32 v[234:235], v2 offset0:34 offset1:35
    v_bfe_u32 v23, v0, 5, 1
    v_mad_u32_u24 v11, v23, 8, v11
    v_lshlrev_b32 v11, 6, v11
    ds_read2_b32 a[232:233], v2 offset0:48 offset1:49
    ds_read2_b32 a[234:235], v2 offset0:50 offset1:51
    v_bfe_u32 v23, v0, 4, 1
    v_lshl_add_u32 v11, v23, 5, v11
    v_and_b32 v23, 3, v0
    ds_read2_b32 v[172:173], v2 offset0:128 offset1:129
    ds_read2_b32 v[174:175], v2 offset0:130 offset1:131
    v_lshl_add_u32 v11, v23, 3, v11
    v_add_u32 v16, s80, v11
    v_add_u32 v17, 57344, v16
    ds_read2_b32 v[204:205], v2 offset0:144 offset1:145
    ds_read2_b32 v[206:207], v2 offset0:146 offset1:147
    v_bfe_u32 v23, v0, 4, 1
    v_mul_u32_u24 v23, 224, v23
    v_bfe_u32 v3, v0, 5, 1
    v_lshl_add_u32 v23, v3, 9, v23
    ds_read2_b32 v[236:237], v2 offset0:160 offset1:161
    ds_read2_b32 v[238:239], v2 offset0:162 offset1:163
    v_add_u32 v18, s81, v11
    v_add_u32 v20, v17, v23
    v_add_u32 v21, v18, v23
    ds_read2_b32 a[236:237], v2 offset0:176 offset1:177
    ds_read2_b32 a[238:239], v2 offset0:178 offset1:179
    v_add_u32 v2, 1024, v2
    v_lshrrev_b32 v30, 1, v9
    v_add_u32 v30, 123904, v30
    v_and_b32 v5, 3, v0
    ds_read2_b32 v[176:177], v2 offset0:0 offset1:1
    ds_read2_b32 v[178:179], v2 offset0:2 offset1:3
    v_bfe_u32 v6, v0, 2, 2
    v_lshlrev_b32 v4, 4, v5
    v_lshl_add_u32 v5, v6, 3, v5
    ds_read2_b32 v[208:209], v2 offset0:16 offset1:17
    ds_read2_b32 v[210:211], v2 offset0:18 offset1:19
    v_lshl_add_u32 v4, v6, 10, v4
    v_bfe_u32 v6, v0, 4, 1
    v_bfe_u32 v28, v0, 5, 1
    ds_read2_b32 v[240:241], v2 offset0:32 offset1:33
    ds_read2_b32 v[242:243], v2 offset0:34 offset1:35
    v_lshl_add_u32 v7, v5, 1, v6
    v_lshl_add_u32 v7, v28, 3, v7
    v_lshl_add_u32 v4, v6, 12, v4
    v_lshl_add_u32 v4, v28, 9, v4
    ds_read2_b32 a[240:241], v2 offset0:48 offset1:49
    ds_read2_b32 a[242:243], v2 offset0:50 offset1:51
    v_sub_u32 v5, v25, v5
    s_mul_i32 s61, s62, 4608
    s_lshl_b32 s60, s63, 8
    ds_read2_b32 v[180:181], v2 offset0:128 offset1:129
    ds_read2_b32 v[182:183], v2 offset0:130 offset1:131
    s_add_u32 s60, s60, s61
    s_add_u32 s60, s60, 115120
    v_lshl_add_u32 v5, v5, 4, s60
    ds_read2_b32 v[212:213], v2 offset0:144 offset1:145
    ds_read2_b32 v[214:215], v2 offset0:146 offset1:147
    s_lshl_b32 s60, s63, 10
    s_sub_u32 s60, s61, s60
    s_add_u32 s60, s60, 116216
    ds_read2_b32 v[244:245], v2 offset0:160 offset1:161
    ds_read2_b32 v[246:247], v2 offset0:162 offset1:163
    v_lshlrev_b32 v6, 3, v7
    v_sub_u32 v6, s60, v6
    s_lshl_b32 s61, s63, 11
    s_add_u32 s60, s61, 123904
    ds_read2_b32 a[244:245], v2 offset0:176 offset1:177
    ds_read2_b32 a[246:247], v2 offset0:178 offset1:179
    v_add_u32 v2, 1024, v2
    v_lshl_add_u32 v7, v7, 4, s60
    s_lshl_b32 s60, s62, 12
    s_add_u32 s60, s60, 155648
    ds_read2_b32 v[184:185], v2 offset0:0 offset1:1
    ds_read2_b32 v[186:187], v2 offset0:2 offset1:3
    v_add_u32 v28, s60, v24
    s_sub_u32 s61, 2048, s61
    v_add_u32 v29, s61, v28
    ds_read2_b32 v[216:217], v2 offset0:16 offset1:17
    ds_read2_b32 v[218:219], v2 offset0:18 offset1:19
    s_mul_i32 s60, s53, 8448
    s_lshl_b32 s61, s62, 13
    s_add_u32 s20, s60, s61
    ds_read2_b32 v[248:249], v2 offset0:32 offset1:33
    ds_read2_b32 v[250:251], v2 offset0:34 offset1:35
    s_add_u32 s20, s20, 269312
    s_lshl_b32 s61, s62, 6
    s_add_u32 s60, s60, s61
    ds_read2_b32 a[248:249], v2 offset0:48 offset1:49
    ds_read2_b32 a[250:251], v2 offset0:50 offset1:51
    s_lshl_b32 s61, s63, 7
    s_add_u32 s60, s60, s61
    s_add_u32 s25, s60, 393216
    s_add_u32 s68, s20, 4096
    ds_read2_b32 v[188:189], v2 offset0:128 offset1:129
    ds_read2_b32 v[190:191], v2 offset0:130 offset1:131
    s_mov_b32 s24, 4096
    s_lshr_b32 s23, s53, 2
    s_lshl_b32 s23, s23, 4
    ds_read2_b32 v[220:221], v2 offset0:144 offset1:145
    ds_read2_b32 v[222:223], v2 offset0:146 offset1:147
    s_add_u32 s23, s23, 20480
    s_mul_i32 s22, s53, 16640
    s_lshl_b32 s60, s48, 10
    ds_read2_b32 v[252:253], v2 offset0:160 offset1:161
    ds_read2_b32 v[254:255], v2 offset0:162 offset1:163
    s_add_u32 s22, s22, s60
    s_add_u32 s22, s22, 4177920
    s_lshl_b32 s21, s53, 5
    ds_read2_b32 a[252:253], v2 offset0:176 offset1:177
    ds_read2_b32 a[254:255], v2 offset0:178 offset1:179
    s_add_u32 s21, s21, 122880
    s_lshl_b32 s27, s53, 8
    s_add_u32 s27, s27, 196608
    s_waitcnt vmcnt(0) lgkmcnt(15)
    s_barrier
    s_cmp_lg_u32 s48, 0
    s_cbranch_scc1 noflag_4
    buffer_store_dwordx4 v[12:15], v27, s[16:19], s59 offen offset:0 sc1
noflag_4:
    s_lshr_b32 s60, s48, 1
    s_lshl1_add_u32 s60, s2, s60
    s_mulk_i32 s60, 5376
    s_and_b32 s61, s48, 1
    v_bfe_u32 v22, v0, 4, 2
    v_min_u32 v22, 2, v22
    s_mul_i32 s61, s61, 3
    v_add_u32 v22, s61, v22
    s_addk_i32 s60, 4608
    v_lshlrev_b32 v22, 7, v22
    buffer_load_dword v1, v22, s[8:11], s60 offen
    v_and_b32 v22, 63, v0
    v_min_u32 v22, 13, v22
    v_lshlrev_b32 v22, 7, v22
    s_lshr_b32 s60, s2, 3
    s_lshl_b32 s60, s60, 2
    s_add_u32 s60, s60, s48
    s_lshr_b32 s61, s49, 1
    s_lshl_b32 s60, s60, 2
    s_add_u32 s60, s60, s61
    s_lshl_b32 s60, s60, 1
    s_and_b32 s61, s49, 1
    s_add_u32 s60, s60, s61
    s_mul_i32 s60, s60, 1792
    buffer_load_dword v1, v22, s[28:31], s60 offen
    buffer_load_dword v1, v22, s[32:35], s60 offen
    s_waitcnt vmcnt(0)
    buffer_load_dwordx4 v[144:147], v9, s[16:19], s24 offen offset:0 sc1
    buffer_load_dwordx4 v[148:151], v9, s[16:19], s24 offen offset:1024 sc1
    buffer_load_dwordx4 v[152:155], v9, s[16:19], s24 offen offset:2048 sc1
    buffer_load_dwordx4 v[156:159], v9, s[16:19], s24 offen offset:3072 sc1
    buffer_load_dwordx4 v[88:91], v8, s[16:19], s23 offen sc1
    s_add_u32 m0, s80, 57344
    s_nop 0
    buffer_load_dwordx4 v10, s[28:31], 0 offen offset:0 lds
    buffer_load_dwordx4 v10, s[28:31], s82 offen offset:1024 lds
    buffer_load_dwordx4 v10, s[28:31], s83 offen offset:2048 lds
    buffer_load_dwordx4 v10, s[28:31], s84 offen offset:3072 lds
    s_add_u32 m0, s80, 61440
    s_nop 0
    buffer_load_dwordx4 v10, s[32:35], 0 offen offset:0 lds
    buffer_load_dwordx4 v10, s[32:35], s82 offen offset:1024 lds
    s_waitcnt vmcnt(7)
    v_cmp_ne_u64 vcc, s[46:47], v[146:147]
    v_cmp_ne_u64 s[72:73], s[46:47], v[150:151]
    v_cmp_ne_u64 s[74:75], s[46:47], v[154:155]
    s_or_b64 vcc, vcc, s[72:73]
    v_cmp_ne_u64 s[76:77], s[46:47], v[158:159]
    s_or_b64 vcc, vcc, s[74:75]
    s_or_b64 vcc, vcc, s[76:77]
    s_cbranch_vccnz retry_5
back_6:
    s_barrier
    buffer_load_dwordx4 v[128:131], v7, s[16:19], s20 offen offset:0 sc1
    buffer_load_dwordx4 v[132:135], v7, s[16:19], s20 offen offset:1024 sc1
    buffer_load_dwordx4 v[136:139], v7, s[16:19], s68 offen offset:0 sc1
    buffer_load_dwordx4 v[140:143], v7, s[16:19], s68 offen offset:1024 sc1
    buffer_load_dwordx4 v10, s[32:35], s83 offen offset:2048 lds
    buffer_load_dwordx4 v10, s[32:35], s84 offen offset:3072 lds
    v_add_u32 v10, 0x38000, v10
    s_add_u32 m0, s80, 65536
    s_nop 0
    buffer_load_dwordx4 v10, s[28:31], 0 offen offset:0 lds
    buffer_load_dwordx4 v10, s[28:31], s82 offen offset:1024 lds
    v_and_b32 v146, s56, v144
    v_rcp_f32 v146, v146
    v_lshlrev_b32 v144, 16, v144
    v_mul_f32 v144, -v144, v146
    v_and_b32 v147, s56, v145
    v_rcp_f32 v147, v147
    v_lshlrev_b32 v145, 16, v145
    v_mul_f32 v145, -v145, v147
    ds_write_b64 v30, v[146:147] offset:0
    ds_write_b64 v30, v[144:145] offset:8192
    v_and_b32 v150, s56, v148
    v_rcp_f32 v150, v150
    v_lshlrev_b32 v148, 16, v148
    v_mul_f32 v148, -v148, v150
    v_and_b32 v151, s56, v149
    v_rcp_f32 v151, v151
    v_lshlrev_b32 v149, 16, v149
    v_mul_f32 v149, -v149, v151
    ds_write_b64 v30, v[150:151] offset:512
    ds_write_b64 v30, v[148:149] offset:8704
    v_and_b32 v154, s56, v152
    v_rcp_f32 v154, v154
    v_lshlrev_b32 v152, 16, v152
    v_mul_f32 v152, -v152, v154
    v_and_b32 v155, s56, v153
    v_rcp_f32 v155, v155
    v_lshlrev_b32 v153, 16, v153
    v_mul_f32 v153, -v153, v155
    ds_write_b64 v30, v[154:155] offset:1024
    ds_write_b64 v30, v[152:153] offset:9216
    v_and_b32 v158, s56, v156
    v_rcp_f32 v158, v158
    v_lshlrev_b32 v156, 16, v156
    v_mul_f32 v156, -v156, v158
    v_and_b32 v159, s56, v157
    v_rcp_f32 v159, v159
    v_lshlrev_b32 v157, 16, v157
    v_mul_f32 v157, -v157, v159
    ds_write_b64 v30, v[158:159] offset:1536
    ds_write_b64 v30, v[156:157] offset:9728
    s_waitcnt vmcnt(14)
    v_cmp_ne_u64 vcc, s[46:47], v[90:91]
    s_cbranch_vccnz retry_7
back_8:
    s_bitcmp1_b32 s53, 1
    s_cselect_b64 vcc, -1, 0
    v_cndmask_b32 v88, v88, v89, vcc
    s_lshl_b32 s61, s62, 4
    v_lshrrev_b32 v88, s61, v88
    v_lshlrev_b32 v88, 16, v88
    v_add_f32 v89, 1.0, v88
    v_cvt_pk_bf16_f32 v89, v89, v89
    v_lshlrev_b32 v89, 16, v89
    v_mov_b32_dpp v26, v88 quad_perm:[0,0,0,0] row_mask:0xf bank_mask:0xf
    v_mov_b32_dpp v23, v88 quad_perm:[2,2,2,2] row_mask:0xf bank_mask:0xf
    v_mov_b32_dpp v25, v89 quad_perm:[1,1,1,1] row_mask:0xf bank_mask:0xf
    v_mov_b32_dpp v22, v89 quad_perm:[3,3,3,3] row_mask:0xf bank_mask:0xf
    v_mul_f32 v25, v25, v23
    v_mul_f32 v26, v26, v23
    v_mov_b32 v23, 0x2b800000
    v_cmp_eq_f32 vcc, 0, v22
    s_nop 1
    v_cndmask_b32 v22, v22, v23, vcc
    v_bfe_u32 v3, v0, 3, 3
    v_mul_u32_u24 v3, 16896, v3
    v_and_b32 v2, 7, v0
    v_lshl_add_u32 v3, v2, 4, v3
    s_mul_i32 s65, s48, 7168
    v_min_u32 v2, 880, v24
    s_mul_i32 s60, s48, 3584
    s_add_u32 s60, s60, 122880
    v_lshl_add_u32 v2, v2, 2, s60
    s_lshl_b32 s61, s54, 9
    s_add_u32 s61, s61, 393216
    s_mul_i32 s5, s48, 946176
    s_add_u32 s5, s5, s61
    s_mul_i32 s60, s62, 1892224
    s_sub_u32 s4, s5, s60
    s_mov_b32 s88, 49152
    s_add_u32 s89, s21, 49152
    s_waitcnt vmcnt(13)
    ds_read_b64_tr_b16 a[0:1], v17 offset:0
    ds_read_b64_tr_b16 a[2:3], v17 offset:256
    s_waitcnt vmcnt(12)
    ds_read_b64_tr_b16 a[4:5], v17 offset:1024
    ds_read_b64_tr_b16 a[6:7], v17 offset:1280
    s_waitcnt vmcnt(11)
    ds_read_b64_tr_b16 a[8:9], v17 offset:2048
    ds_read_b64_tr_b16 a[10:11], v17 offset:2304
    s_waitcnt vmcnt(10)
    ds_read_b64_tr_b16 a[12:13], v17 offset:3072
    ds_read_b64_tr_b16 a[14:15], v17 offset:3328
    s_waitcnt vmcnt(9)
    ds_read_b64_tr_b16 a[112:113], v17 offset:4096
    ds_read_b64_tr_b16 a[114:115], v17 offset:4352
    s_waitcnt vmcnt(8)
    ds_read_b64_tr_b16 a[116:117], v17 offset:5120
    ds_read_b64_tr_b16 a[118:119], v17 offset:5376
    s_waitcnt vmcnt(7)
    ds_write_b64 v6, v[128:129] offset:2560
    s_waitcnt vmcnt(6)
    ds_write_b64 v6, v[132:133] offset:2048
    s_waitcnt vmcnt(5)
    ds_write_b64 v6, v[136:137] offset:512
    s_waitcnt vmcnt(4)
    ds_write_b64 v6, v[140:141] offset:0
    s_waitcnt lgkmcnt(0)
    s_barrier
    ds_read_b128 v[64:67], v5 offset:3584
    ds_read_b128 v[68:71], v5 offset:3072
    ds_read_b128 v[72:75], v5 offset:2560
    ds_read_b128 v[76:79], v5 offset:2048
    ds_read_b128 v[80:83], v5 offset:3648
    s_waitcnt lgkmcnt(4)
    v_mfma_f32_16x16x32_bf16 v[96:99], v[160:163], v[64:67], 0
    ds_read_b128 v[84:87], v5 offset:3136
    buffer_load_dwordx4 v10, s[28:31], s83 offen offset:2048 lds
    v_mfma_f32_16x16x32_bf16 v[100:103], v[164:167], v[64:67], 0
    ds_read_b128 v[144:147], v7 offset:0
    ds_read_b128 v[148:151], v7 offset:8192
    v_mfma_f32_16x16x32_bf16 v[104:107], v[168:171], v[64:67], 0
    v_lshlrev_b32 v32, 16, v130
    v_and_b32 v33, s56, v130
    v_mfma_f32_16x16x32_bf16 v[108:111], v[172:175], v[64:67], 0
    v_lshlrev_b32 v34, 16, v131
    buffer_load_dwordx4 v10, s[28:31], s84 offen offset:3072 lds
    s_waitcnt lgkmcnt(6)
    v_mfma_f32_16x16x32_bf16 v[100:103], v[160:163], v[68:71], v[100:103]
    ds_read_b128 v[64:67], v5 offset:2624
    v_and_b32 v35, s56, v131
    v_mfma_f32_16x16x32_bf16 v[104:107], v[164:167], v[68:71], v[104:107]
    s_waitcnt lgkmcnt(1)
    v_fma_f32 v48, v32, v144, v148
    v_mfma_f32_16x16x32_bf16 v[108:111], v[168:171], v[68:71], v[108:111]
    v_fma_f32 v48, v48, v25, v26
    v_fma_f32 v49, v33, v145, v149
    v_mfma_f32_16x16x32_bf16 v[104:107], v[160:163], v[72:75], v[104:107]
    ds_read_b128 v[68:71], v5 offset:2112
    s_add_u32 m0, s80, 69632
    s_nop 0
    buffer_load_dwordx4 v10, s[32:35], 0 offen offset:0 lds
    v_mfma_f32_16x16x32_bf16 v[108:111], v[164:167], v[72:75], v[108:111]
    v_fma_f32 v49, v49, v25, v26
    v_fma_f32 v50, v34, v146, v150
    v_mfma_f32_16x16x32_bf16 v[108:111], v[160:163], v[76:79], v[108:111]
    ds_read_b128 v[72:75], v5 offset:3712
    v_fma_f32 v50, v50, v25, v26
    v_mfma_f32_16x16x32_bf16 v[96:99], v[192:195], v[80:83], v[96:99]
    ds_read_b128 v[76:79], v5 offset:3200
    v_fma_f32 v51, v35, v147, v151
    v_mfma_f32_16x16x32_bf16 v[100:103], v[196:199], v[80:83], v[100:103]
    buffer_load_dwordx4 v10, s[32:35], s82 offen offset:1024 lds
    v_fma_f32 v51, v51, v25, v26
    v_mfma_f32_16x16x32_bf16 v[104:107], v[200:203], v[80:83], v[104:107]
    ds_read_b128 v[152:155], v7 offset:1024
    ds_read_b128 v[156:159], v7 offset:9216
    v_mfma_f32_16x16x32_bf16 v[108:111], v[204:207], v[80:83], v[108:111]
    v_lshlrev_b32 v36, 16, v134
    v_and_b32 v37, s56, v134
    v_mfma_f32_16x16x32_bf16 v[100:103], v[192:195], v[84:87], v[100:103]
    ds_read_b128 v[80:83], v5 offset:2688
    v_lshlrev_b32 v38, 16, v135
    v_mfma_f32_16x16x32_bf16 v[104:107], v[196:199], v[84:87], v[104:107]
    v_add_u32 v10, 0x1c000, v10
    s_add_u32 m0, s80, 0
    s_nop 0
    buffer_load_dwordx4 v10, s[32:35], 0 offen offset:0 lds
    v_mfma_f32_16x16x32_bf16 v[108:111], v[200:203], v[84:87], v[108:111]
    v_and_b32 v39, s56, v135
    s_waitcnt lgkmcnt(1)
    v_mfma_f32_16x16x32_bf16 v[104:107], v[192:195], v[64:67], v[104:107]
    ds_read_b128 v[84:87], v5 offset:2176
    v_fma_f32 v52, v36, v152, v156
    v_mfma_f32_16x16x32_bf16 v[108:111], v[196:199], v[64:67], v[108:111]
    buffer_load_dwordx4 v10, s[32:35], s82 offen offset:1024 lds
    v_fma_f32 v52, v52, v25, v26
    v_mfma_f32_16x16x32_bf16 v[108:111], v[192:195], v[68:71], v[108:111]
    ds_read_b128 v[64:67], v5 offset:3776
    v_fma_f32 v53, v37, v153, v157
    v_mfma_f32_16x16x32_bf16 v[96:99], v[224:227], v[72:75], v[96:99]
    ds_read_b128 v[68:71], v5 offset:3264
    v_fma_f32 v53, v53, v25, v26
    v_mfma_f32_16x16x32_bf16 v[100:103], v[228:231], v[72:75], v[100:103]
    v_fma_f32 v54, v38, v154, v158
    v_fma_f32 v54, v54, v25, v26
    v_mfma_f32_16x16x32_bf16 v[104:107], v[232:235], v[72:75], v[104:107]
    v_add_u32 v10, 0x1c000, v10
    s_add_u32 m0, s80, 2048
    s_nop 0
    buffer_load_dwordx4 v10, s[28:31], 0 offen offset:0 lds
    v_mfma_f32_16x16x32_bf16 v[108:111], v[236:239], v[72:75], v[108:111]
    v_fma_f32 v55, v39, v155, v159
    v_fma_f32 v55, v55, v25, v26
    v_mfma_f32_16x16x32_bf16 v[100:103], v[224:227], v[76:79], v[100:103]
    ds_read_b128 v[72:75], v5 offset:2752
    v_mfma_f32_16x16x32_bf16 v[104:107], v[228:231], v[76:79], v[104:107]
    v_mfma_f32_16x16x32_bf16 v[108:111], v[232:235], v[76:79], v[108:111]
    buffer_load_dwordx4 v10, s[28:31], s82 offen offset:1024 lds
    s_waitcnt lgkmcnt(4)
    v_mfma_f32_16x16x32_bf16 v[104:107], v[224:227], v[80:83], v[104:107]
    ds_read_b128 v[76:79], v5 offset:2240
    v_mfma_f32_16x16x32_bf16 v[108:111], v[228:231], v[80:83], v[108:111]
    s_waitcnt lgkmcnt(4)
    v_mfma_f32_16x16x32_bf16 v[108:111], v[224:227], v[84:87], v[108:111]
    ds_read_b128 v[80:83], v5 offset:3584
    s_waitcnt lgkmcnt(4)
    v_mfma_f32_16x16x32_bf16 v[96:99], a[224:227], v[64:67], v[96:99]
    ds_read_b128 v[84:87], v5 offset:3072
    buffer_load_dwordx4 v10, s[28:31], s83 offen offset:2048 lds
    v_mfma_f32_16x16x32_bf16 v[100:103], a[228:231], v[64:67], v[100:103]
    s_waitcnt vmcnt(12)
    ds_read_b64_tr_b16 a[120:121], v17 offset:6144
    ds_read_b64_tr_b16 a[122:123], v17 offset:6400
    v_mfma_f32_16x16x32_bf16 v[104:107], a[232:235], v[64:67], v[104:107]
    s_waitcnt vmcnt(11)
    ds_read_b64_tr_b16 a[124:125], v17 offset:7168
    ds_read_b64_tr_b16 a[126:127], v17 offset:7424
    v_mfma_f32_16x16x32_bf16 v[108:111], a[236:239], v[64:67], v[108:111]
    buffer_load_dwordx4 v10, s[28:31], s84 offen offset:3072 lds
    s_waitcnt lgkmcnt(8)
    v_mfma_f32_16x16x32_bf16 v[100:103], a[224:227], v[68:71], v[100:103]
    ds_read_b128 v[64:67], v5 offset:2560
    v_mfma_f32_16x16x32_bf16 v[104:107], a[228:231], v[68:71], v[104:107]
    s_waitcnt vmcnt(11)
    ds_read_b64_tr_b16 a[16:17], v17 offset:8192
    ds_read_b64_tr_b16 a[18:19], v17 offset:8448
    v_mfma_f32_16x16x32_bf16 v[108:111], a[232:235], v[68:71], v[108:111]
    s_waitcnt vmcnt(10)
    ds_read_b64_tr_b16 a[20:21], v17 offset:9216
    ds_read_b64_tr_b16 a[22:23], v17 offset:9472
    s_waitcnt lgkmcnt(12)
    v_mfma_f32_16x16x32_bf16 v[104:107], a[224:227], v[72:75], v[104:107]
    ds_read_b128 v[68:71], v5 offset:2048
    v_mfma_f32_16x16x32_bf16 v[108:111], a[228:231], v[72:75], v[108:111]
    s_waitcnt lgkmcnt(12)
    v_mfma_f32_16x16x32_bf16 v[108:111], a[224:227], v[76:79], v[108:111]
    ds_read_b128 v[72:75], v5 offset:1536
    s_waitcnt lgkmcnt(12)
    v_mfma_f32_16x16x32_bf16 v[112:115], v[176:179], v[80:83], 0
    ds_read_b128 v[76:79], v5 offset:1024
    v_mfma_f32_16x16x32_bf16 v[116:119], v[180:183], v[80:83], 0
    v_mfma_f32_16x16x32_bf16 v[120:123], v[184:187], v[80:83], 0
    v_mfma_f32_16x16x32_bf16 v[124:127], v[188:191], v[80:83], 0
    s_cmp_eq_u32 s63, 0
    s_cbranch_scc0 half_9
    ds_write_b128 v28, v[104:107] offset:0
    ds_write_b128 v28, v[108:111] offset:1024
    s_branch join_10
half_9:
    ds_write_b128 v28, v[96:99] offset:2048
    ds_write_b128 v28, v[100:103] offset:3072
join_10:
    s_waitcnt lgkmcnt(14)
    v_mfma_f32_16x16x32_bf16 v[112:115], v[172:175], v[84:87], v[112:115]
    ds_read_b128 v[80:83], v5 offset:512
    v_mfma_f32_16x16x32_bf16 v[116:119], v[176:179], v[84:87], v[116:119]
    v_mfma_f32_16x16x32_bf16 v[120:123], v[180:183], v[84:87], v[120:123]
    v_mfma_f32_16x16x32_bf16 v[124:127], v[184:187], v[84:87], v[124:127]
    s_waitcnt lgkmcnt(10)
    v_mfma_f32_16x16x32_bf16 v[112:115], v[168:171], v[64:67], v[112:115]
    ds_read_b128 v[84:87], v5 offset:0
    s_waitcnt lgkmcnt(2)
    s_barrier
    ds_read_b128 v[128:131], v29 offset:0
    ds_read_b128 v[132:135], v29 offset:1024
    v_mfma_f32_16x16x32_bf16 v[116:119], v[172:175], v[64:67], v[116:119]
    s_add_u32 m0, s80, 6144
    s_nop 0
    buffer_load_dwordx4 v10, s[32:35], 0 offen offset:0 lds
    v_mfma_f32_16x16x32_bf16 v[120:123], v[176:179], v[64:67], v[120:123]
    buffer_load_dwordx4 v10, s[32:35], s82 offen offset:1024 lds
    v_mfma_f32_16x16x32_bf16 v[124:127], v[180:183], v[64:67], v[124:127]
    v_mfma_f32_16x16x32_bf16 v[112:115], v[164:167], v[68:71], v[112:115]
    ds_read_b128 v[64:67], v5 offset:3648
    v_mfma_f32_16x16x32_bf16 v[116:119], v[168:171], v[68:71], v[116:119]
    s_waitcnt lgkmcnt(1)
    s_cmp_eq_u32 s63, 0
    s_cbranch_scc0 half_11
    v_add_f32 v128, v128, v96
    v_add_f32 v129, v129, v97
    v_add_f32 v130, v130, v98
    v_add_f32 v131, v131, v99
    v_add_f32 v132, v132, v100
    v_add_f32 v133, v133, v101
    v_add_f32 v134, v134, v102
    v_add_f32 v135, v135, v103
    s_branch join_12
half_11:
    v_add_f32 v128, v128, v104
    v_add_f32 v129, v129, v105
    v_add_f32 v130, v130, v106
    v_add_f32 v131, v131, v107
    v_add_f32 v132, v132, v108
    v_add_f32 v133, v133, v109
    v_add_f32 v134, v134, v110
    v_add_f32 v135, v135, v111
join_12:
    v_mfma_f32_16x16x32_bf16 v[120:123], v[172:175], v[68:71], v[120:123]
    v_fma_f32 v128, v48, v128, v32
    v_mul_f32 v48, v128, v22
    v_fma_f32 v129, v49, v129, v33
    v_mul_f32 v49, v129, v22
    v_cvt_pk_bf16_f32 v88, v48, v49
    v_mfma_f32_16x16x32_bf16 v[124:127], v[176:179], v[68:71], v[124:127]
    v_fma_f32 v130, v50, v130, v34
    v_mul_f32 v50, v130, v22
    v_fma_f32 v131, v51, v131, v35
    v_mul_f32 v51, v131, v22
    v_cvt_pk_bf16_f32 v89, v50, v51
    v_mfma_f32_16x16x32_bf16 v[112:115], v[160:163], v[72:75], v[112:115]
    ds_read_b128 v[68:71], v5 offset:3136
    v_fma_f32 v132, v52, v132, v36
    v_mul_f32 v52, v132, v22
    v_fma_f32 v133, v53, v133, v37
    v_mul_f32 v53, v133, v22
    v_cvt_pk_bf16_f32 v90, v52, v53
    v_fma_f32 v134, v54, v134, v38
    v_mfma_f32_16x16x32_bf16 v[116:119], v[164:167], v[72:75], v[116:119]
    v_mul_f32 v54, v134, v22
    v_fma_f32 v135, v55, v135, v39
    v_mul_f32 v55, v135, v22
    v_cvt_pk_bf16_f32 v91, v54, v55
    v_permlane16_swap_b32 v88, v90
    v_mfma_f32_16x16x32_bf16 v[120:123], v[168:171], v[72:75], v[120:123]
    v_permlane16_swap_b32 v89, v91
    buffer_load_dwordx4 v10, s[32:35], s83 offen offset:2048 lds
    v_mfma_f32_16x16x32_bf16 v[124:127], v[172:175], v[72:75], v[124:127]
    buffer_store_dwordx4 v[88:91], v4, s[16:19], s25 offen offset:0 sc1
    v_mfma_f32_16x16x32_bf16 v[116:119], v[160:163], v[76:79], v[116:119]
    ds_read_b128 v[72:75], v5 offset:2624
    ds_read_b128 v[144:147], v7 offset:4096
    ds_read_b128 v[148:151], v7 offset:12288
    v_mfma_f32_16x16x32_bf16 v[120:123], v[164:167], v[76:79], v[120:123]
    s_waitcnt vmcnt(13)
    ds_read_b64_tr_b16 a[24:25], v17 offset:10240
    ds_read_b64_tr_b16 a[26:27], v17 offset:10496
    v_mfma_f32_16x16x32_bf16 v[124:127], v[168:171], v[76:79], v[124:127]
    v_add_u32 v10, 0x2a000, v10
    s_add_u32 m0, s80, 57344
    s_nop 0
    buffer_load_dwordx4 v10, s[32:35], 0 offen offset:0 lds
    v_mfma_f32_16x16x32_bf16 v[120:123], v[160:163], v[80:83], v[120:123]
    ds_read_b128 v[76:79], v5 offset:2112
    v_lshlrev_b32 v40, 16, v138
    v_mfma_f32_16x16x32_bf16 v[124:127], v[164:167], v[80:83], v[124:127]
    s_waitcnt vmcnt(13)
    ds_read_b64_tr_b16 a[28:29], v17 offset:11264
    ds_read_b64_tr_b16 a[30:31], v17 offset:11520
    v_mfma_f32_16x16x32_bf16 v[124:127], v[160:163], v[84:87], v[124:127]
    ds_read_b128 v[80:83], v5 offset:1600
    v_add_u32 v10, 0xe000, v10
    s_add_u32 m0, s80, 58368
    s_nop 0
    buffer_load_dwordx4 v10, s[28:31], 0 offen offset:0 lds
    s_waitcnt lgkmcnt(10)
    v_mfma_f32_16x16x32_bf16 v[112:115], v[208:211], v[64:67], v[112:115]
    ds_read_b128 v[84:87], v5 offset:1088
    v_and_b32 v41, s56, v138
    v_mfma_f32_16x16x32_bf16 v[116:119], v[212:215], v[64:67], v[116:119]
    s_waitcnt vmcnt(13)
    ds_read_b64_tr_b16 a[128:129], v17 offset:12288
    ds_read_b64_tr_b16 a[130:131], v17 offset:12544
    v_mfma_f32_16x16x32_bf16 v[120:123], v[216:219], v[64:67], v[120:123]
    buffer_load_dwordx4 v10, s[28:31], s82 offen offset:1024 lds
    v_lshlrev_b32 v42, 16, v139
    v_mfma_f32_16x16x32_bf16 v[124:127], v[220:223], v[64:67], v[124:127]
    s_waitcnt vmcnt(13)
    ds_read_b64_tr_b16 a[132:133], v17 offset:13312
    ds_read_b64_tr_b16 a[134:135], v17 offset:13568
    s_waitcnt lgkmcnt(14)
    v_mfma_f32_16x16x32_bf16 v[112:115], v[204:207], v[68:71], v[112:115]
    ds_read_b128 v[64:67], v5 offset:576
    v_and_b32 v43, s56, v139
    v_mfma_f32_16x16x32_bf16 v[116:119], v[208:211], v[68:71], v[116:119]
    s_waitcnt vmcnt(12)
    ds_read_b64_tr_b16 a[136:137], v16 offset:0
    ds_read_b64_tr_b16 a[138:139], v16 offset:256
    v_mfma_f32_16x16x32_bf16 v[120:123], v[212:215], v[68:71], v[120:123]
    buffer_load_dwordx4 v10, s[28:31], s83 offen offset:2048 lds
    s_waitcnt lgkmcnt(14)
    v_mfma_f32_16x16x32_bf16 v[124:127], v[216:219], v[68:71], v[124:127]
    s_waitcnt vmcnt(12)
    ds_read_b64_tr_b16 a[140:141], v16 offset:1024
    ds_read_b64_tr_b16 a[142:143], v16 offset:1280
    v_mfma_f32_16x16x32_bf16 v[112:115], v[200:203], v[72:75], v[112:115]
    ds_read_b128 v[68:71], v5 offset:64
    v_fma_f32 v56, v40, v144, v148
    v_mfma_f32_16x16x32_bf16 v[116:119], v[204:207], v[72:75], v[116:119]
    buffer_load_dwordx4 v10, s[28:31], s84 offen offset:3072 lds
    v_fma_f32 v56, v56, v25, v26
    v_mfma_f32_16x16x32_bf16 v[120:123], v[208:211], v[72:75], v[120:123]
    s_waitcnt vmcnt(12)
    ds_read_b64_tr_b16 a[32:33], v16 offset:2048
    ds_read_b64_tr_b16 a[34:35], v16 offset:2304
    v_mfma_f32_16x16x32_bf16 v[124:127], v[212:215], v[72:75], v[124:127]
    s_waitcnt vmcnt(11)
    ds_read_b64_tr_b16 a[36:37], v16 offset:3072
    ds_read_b64_tr_b16 a[38:39], v16 offset:3328
    s_waitcnt lgkmcnt(15)
    v_mfma_f32_16x16x32_bf16 v[112:115], v[196:199], v[76:79], v[112:115]
    ds_read_b128 v[72:75], v5 offset:3712
    v_fma_f32 v57, v41, v145, v149
    v_mfma_f32_16x16x32_bf16 v[116:119], v[200:203], v[76:79], v[116:119]
    s_waitcnt vmcnt(10)
    ds_read_b64_tr_b16 a[40:41], v16 offset:4096
    ds_read_b64_tr_b16 a[42:43], v16 offset:4352
    v_mfma_f32_16x16x32_bf16 v[120:123], v[204:207], v[76:79], v[120:123]
    s_waitcnt vmcnt(9)
    ds_read_b64_tr_b16 a[44:45], v16 offset:5120
    ds_read_b64_tr_b16 a[46:47], v16 offset:5376
    v_mfma_f32_16x16x32_bf16 v[124:127], v[208:211], v[76:79], v[124:127]
    v_fma_f32 v57, v57, v25, v26
    v_fma_f32 v58, v42, v146, v150
    v_mfma_f32_16x16x32_bf16 v[112:115], v[192:195], v[80:83], v[112:115]
    ds_read_b128 v[76:79], v5 offset:3200
    v_fma_f32 v58, v58, v25, v26
    v_mfma_f32_16x16x32_bf16 v[116:119], v[196:199], v[80:83], v[116:119]
    v_fma_f32 v59, v43, v147, v151
    v_fma_f32 v59, v59, v25, v26
    v_mfma_f32_16x16x32_bf16 v[120:123], v[200:203], v[80:83], v[120:123]
    ds_read_b128 v[152:155], v7 offset:5120
    ds_read_b128 v[156:159], v7 offset:13312
    v_mfma_f32_16x16x32_bf16 v[124:127], v[204:207], v[80:83], v[124:127]
    v_lshlrev_b32 v44, 16, v142
    v_and_b32 v45, s56, v142
    s_waitcnt lgkmcnt(15)
    v_mfma_f32_16x16x32_bf16 v[116:119], v[192:195], v[84:87], v[116:119]
    ds_read_b128 v[80:83], v5 offset:2688
    v_lshlrev_b32 v46, 16, v143
    v_mfma_f32_16x16x32_bf16 v[120:123], v[196:199], v[84:87], v[120:123]
    v_and_b32 v47, s56, v143
    s_waitcnt lgkmcnt(1)
    v_mfma_f32_16x16x32_bf16 v[124:127], v[200:203], v[84:87], v[124:127]
    s_waitcnt vmcnt(8)
    ds_read_b64_tr_b16 a[144:145], v16 offset:6144
    ds_read_b64_tr_b16 a[146:147], v16 offset:6400
    s_waitcnt vmcnt(7)
    ds_read_b64_tr_b16 a[148:149], v16 offset:7168
    ds_read_b64_tr_b16 a[150:151], v16 offset:7424
    s_waitcnt vmcnt(6)
    ds_read_b64_tr_b16 a[152:153], v16 offset:8192
    ds_read_b64_tr_b16 a[154:155], v16 offset:8448
    s_waitcnt vmcnt(5) lgkmcnt(0)
    s_barrier
    s_cmp_lg_u32 s48, 0
    s_cbranch_scc1 noflag_13
    buffer_store_dwordx4 v[12:15], v27, s[16:19], s21 offen offset:0 sc1
noflag_13:
    v_mfma_f32_16x16x32_bf16 v[120:123], v[192:195], v[64:67], v[120:123]
    ds_read_b128 v[84:87], v5 offset:2176
    s_add_u32 m0, s80, 62464
    s_nop 0
    buffer_load_dwordx4 v10, s[32:35], 0 offen offset:0 lds
    v_mfma_f32_16x16x32_bf16 v[124:127], v[196:199], v[64:67], v[124:127]
    v_fma_f32 v60, v44, v152, v156
    v_fma_f32 v60, v60, v25, v26
    v_mfma_f32_16x16x32_bf16 v[124:127], v[192:195], v[68:71], v[124:127]
    ds_read_b128 v[64:67], v5 offset:1664
    v_fma_f32 v61, v45, v153, v157
    v_mfma_f32_16x16x32_bf16 v[112:115], v[240:243], v[72:75], v[112:115]
    ds_read_b128 v[68:71], v5 offset:1152
    buffer_load_dwordx4 v10, s[32:35], s82 offen offset:1024 lds
    v_mfma_f32_16x16x32_bf16 v[116:119], v[244:247], v[72:75], v[116:119]
    v_fma_f32 v61, v61, v25, v26
    v_fma_f32 v62, v46, v154, v158
    v_mfma_f32_16x16x32_bf16 v[120:123], v[248:251], v[72:75], v[120:123]
    v_fma_f32 v62, v62, v25, v26
    v_fma_f32 v63, v47, v155, v159
    v_mfma_f32_16x16x32_bf16 v[124:127], v[252:255], v[72:75], v[124:127]
    v_fma_f32 v63, v63, v25, v26
    v_mfma_f32_16x16x32_bf16 v[112:115], v[236:239], v[76:79], v[112:115]
    ds_read_b128 v[72:75], v5 offset:640
    buffer_load_dwordx4 v10, s[32:35], s83 offen offset:2048 lds
    v_mfma_f32_16x16x32_bf16 v[116:119], v[240:243], v[76:79], v[116:119]
    v_mfma_f32_16x16x32_bf16 v[120:123], v[244:247], v[76:79], v[120:123]
    v_mfma_f32_16x16x32_bf16 v[124:127], v[248:251], v[76:79], v[124:127]
    v_mfma_f32_16x16x32_bf16 v[112:115], v[232:235], v[80:83], v[112:115]
    ds_read_b128 v[76:79], v5 offset:128
    buffer_load_dwordx4 v10, s[32:35], s84 offen offset:3072 lds
    v_mfma_f32_16x16x32_bf16 v[116:119], v[236:239], v[80:83], v[116:119]
    v_mfma_f32_16x16x32_bf16 v[120:123], v[240:243], v[80:83], v[120:123]
    v_mfma_f32_16x16x32_bf16 v[124:127], v[244:247], v[80:83], v[124:127]
    s_waitcnt lgkmcnt(4)
    v_mfma_f32_16x16x32_bf16 v[112:115], v[228:231], v[84:87], v[112:115]
    ds_read_b128 v[80:83], v5 offset:3776
    v_add_u32 v10, 0x38000, v10
    s_add_u32 m0, s80, 66560
    s_nop 0
    buffer_load_dwordx4 v10, s[28:31], 0 offen offset:0 lds
    v_mfma_f32_16x16x32_bf16 v[116:119], v[232:235], v[84:87], v[116:119]
    v_mfma_f32_16x16x32_bf16 v[120:123], v[236:239], v[84:87], v[120:123]
    v_mfma_f32_16x16x32_bf16 v[124:127], v[240:243], v[84:87], v[124:127]
    s_waitcnt lgkmcnt(4)
    v_mfma_f32_16x16x32_bf16 v[112:115], v[224:227], v[64:67], v[112:115]
    ds_read_b128 v[84:87], v5 offset:3264
    buffer_load_dwordx4 v10, s[28:31], s82 offen offset:1024 lds
    v_mfma_f32_16x16x32_bf16 v[116:119], v[228:231], v[64:67], v[116:119]
    v_mfma_f32_16x16x32_bf16 v[120:123], v[232:235], v[64:67], v[120:123]
    v_mfma_f32_16x16x32_bf16 v[124:127], v[236:239], v[64:67], v[124:127]
    s_waitcnt lgkmcnt(4)
    v_mfma_f32_16x16x32_bf16 v[116:119], v[224:227], v[68:71], v[116:119]
    ds_read_b128 v[64:67], v5 offset:2752
    buffer_load_dwordx4 v10, s[28:31], s83 offen offset:2048 lds
    v_mfma_f32_16x16x32_bf16 v[120:123], v[228:231], v[68:71], v[120:123]
    v_mfma_f32_16x16x32_bf16 v[124:127], v[232:235], v[68:71], v[124:127]
    s_waitcnt lgkmcnt(4)
    v_mfma_f32_16x16x32_bf16 v[120:123], v[224:227], v[72:75], v[120:123]
    ds_read_b128 v[68:71], v5 offset:2240
    buffer_load_dwordx4 v10, s[28:31], s84 offen offset:3072 lds
    v_mfma_f32_16x16x32_bf16 v[124:127], v[228:231], v[72:75], v[124:127]
    s_waitcnt lgkmcnt(4)
    v_mfma_f32_16x16x32_bf16 v[124:127], v[224:227], v[76:79], v[124:127]
    ds_read_b128 v[72:75], v5 offset:1728
    s_waitcnt lgkmcnt(4)
    v_mfma_f32_16x16x32_bf16 v[112:115], a[240:243], v[80:83], v[112:115]
    ds_read_b128 v[76:79], v5 offset:1216
    v_mfma_f32_16x16x32_bf16 v[116:119], a[244:247], v[80:83], v[116:119]
    s_waitcnt vmcnt(12)
    ds_read_b64_tr_b16 a[156:157], v17 offset:0
    ds_read_b64_tr_b16 a[158:159], v17 offset:256
    v_mfma_f32_16x16x32_bf16 v[120:123], a[248:251], v[80:83], v[120:123]
    s_add_u32 m0, s80, 70656
    s_nop 0
    buffer_load_dwordx4 v10, s[32:35], 0 offen offset:0 lds
    v_mfma_f32_16x16x32_bf16 v[124:127], a[252:255], v[80:83], v[124:127]
    s_waitcnt vmcnt(12)
    ds_read_b64_tr_b16 a[48:49], v17 offset:1024
    ds_read_b64_tr_b16 a[50:51], v17 offset:1280
    s_waitcnt lgkmcnt(8)
    v_mfma_f32_16x16x32_bf16 v[112:115], a[236:239], v[84:87], v[112:115]
    ds_read_b128 v[80:83], v5 offset:704
    s_waitcnt lgkmcnt(3)
    v_add_u32 v10, 0xe000, v10
    s_add_u32 m0, s80, 57344
    s_nop 0
    buffer_load_dwordx4 v10, s[32:35], 0 offen offset:0 lds
    v_mfma_f32_16x16x32_bf16 v[116:119], a[240:243], v[84:87], v[116:119]
    s_waitcnt vmcnt(12)
    ds_read_b64_tr_b16 a[52:53], v17 offset:2048
    ds_read_b64_tr_b16 a[54:55], v17 offset:2304
    v_mfma_f32_16x16x32_bf16 v[120:123], a[244:247], v[84:87], v[120:123]
    v_mfma_f32_16x16x32_bf16 v[124:127], a[248:251], v[84:87], v[124:127]
    s_waitcnt lgkmcnt(3)
    buffer_load_dwordx4 v10, s[32:35], s82 offen offset:1024 lds
    v_mfma_f32_16x16x32_bf16 v[112:115], a[232:235], v[64:67], v[112:115]
    ds_read_b128 v[84:87], v5 offset:192
    v_mfma_f32_16x16x32_bf16 v[116:119], a[236:239], v[64:67], v[116:119]
    s_waitcnt vmcnt(12)
    ds_read_b64_tr_b16 a[56:57], v17 offset:3072
    ds_read_b64_tr_b16 a[58:59], v17 offset:3328
    v_mfma_f32_16x16x32_bf16 v[120:123], a[240:243], v[64:67], v[120:123]
    v_mfma_f32_16x16x32_bf16 v[124:127], a[244:247], v[64:67], v[124:127]
    s_waitcnt lgkmcnt(3)
    buffer_load_dwordx4 v10, s[32:35], s83 offen offset:2048 lds
    v_mfma_f32_16x16x32_bf16 v[112:115], a[228:231], v[68:71], v[112:115]
    s_waitcnt vmcnt(12)
    ds_read_b64_tr_b16 a[60:61], v17 offset:4096
    ds_read_b64_tr_b16 a[62:63], v17 offset:4352
    v_mfma_f32_16x16x32_bf16 v[116:119], a[232:235], v[68:71], v[116:119]
    v_mfma_f32_16x16x32_bf16 v[120:123], a[236:239], v[68:71], v[120:123]
    v_mfma_f32_16x16x32_bf16 v[124:127], a[240:243], v[68:71], v[124:127]
    s_waitcnt lgkmcnt(2)
    v_add_u32 v10, 0x2a000, v10
    s_add_u32 m0, s80, 60416
    s_nop 0
    buffer_load_dwordx4 v10, s[28:31], 0 offen offset:0 lds
    v_mfma_f32_16x16x32_bf16 v[112:115], a[224:227], v[72:75], v[112:115]
    v_mfma_f32_16x16x32_bf16 v[116:119], a[228:231], v[72:75], v[116:119]
    v_mfma_f32_16x16x32_bf16 v[120:123], a[232:235], v[72:75], v[120:123]
    s_waitcnt lgkmcnt(0)
    buffer_load_dwordx4 v10, s[28:31], s82 offen offset:1024 lds
    v_mfma_f32_16x16x32_bf16 v[124:127], a[236:239], v[72:75], v[124:127]
    v_mfma_f32_16x16x32_bf16 v[116:119], a[224:227], v[76:79], v[116:119]
    v_mfma_f32_16x16x32_bf16 v[120:123], a[228:231], v[76:79], v[120:123]
    v_mfma_f32_16x16x32_bf16 v[124:127], a[232:235], v[76:79], v[124:127]
    v_mfma_f32_16x16x32_bf16 v[120:123], a[224:227], v[80:83], v[120:123]
    v_mfma_f32_16x16x32_bf16 v[124:127], a[228:231], v[80:83], v[124:127]
    v_mfma_f32_16x16x32_bf16 v[124:127], a[224:227], v[84:87], v[124:127]
    s_cmp_eq_u32 s63, 0
    s_cbranch_scc0 L_red1
    s_nop 3
    ds_write_b128 v28, v[120:123] offset:0
    s_nop 0
    ds_write_b128 v28, v[124:127] offset:1024
    s_waitcnt lgkmcnt(0)
    s_barrier
    ds_read_b128 v[64:67], v28 offset:2048
    ds_read_b128 v[68:71], v28 offset:3072
    buffer_load_dwordx4 v[96:99], v2, s[16:19], 0 offen sc1
    s_waitcnt lgkmcnt(1)
    v_pk_add_f32 v[64:65], v[64:65], v[112:113]
    v_pk_add_f32 v[66:67], v[66:67], v[114:115]
    s_waitcnt lgkmcnt(0)
    v_pk_add_f32 v[68:69], v[68:69], v[116:117]
    v_pk_add_f32 v[70:71], v[70:71], v[118:119]
    s_branch L_red2
L_red1:
    s_nop 7
    ds_write_b128 v28, v[112:115] offset:2048
    ds_write_b128 v28, v[116:119] offset:3072
    s_waitcnt lgkmcnt(0)
    s_barrier
    ds_read_b128 v[64:67], v28 offset:0
    ds_read_b128 v[68:71], v28 offset:1024
    buffer_load_dwordx4 v[96:99], v2, s[16:19], 0 offen sc1
    s_waitcnt lgkmcnt(1)
    v_pk_add_f32 v[64:65], v[64:65], v[120:121]
    v_pk_add_f32 v[66:67], v[66:67], v[122:123]
    s_waitcnt lgkmcnt(0)
    v_pk_add_f32 v[68:69], v[68:69], v[124:125]
    v_pk_add_f32 v[70:71], v[70:71], v[126:127]
L_red2:
    v_pk_fma_f32 v[64:65], v[56:57], v[64:65], v[40:41]
    v_pk_fma_f32 v[66:67], v[58:59], v[66:67], v[42:43]
    v_pk_fma_f32 v[68:69], v[60:61], v[68:69], v[44:45]
    v_pk_fma_f32 v[70:71], v[62:63], v[70:71], v[46:47]
    v_pk_mul_f32 v[56:57], v[64:65], v[22:23] op_sel_hi:[1,0]
    v_pk_mul_f32 v[58:59], v[66:67], v[22:23] op_sel_hi:[1,0]
    v_pk_mul_f32 v[60:61], v[68:69], v[22:23] op_sel_hi:[1,0]
    v_pk_mul_f32 v[62:63], v[70:71], v[22:23] op_sel_hi:[1,0]
    v_cvt_pk_bf16_f32 v88, v56, v57
    v_cvt_pk_bf16_f32 v89, v58, v59
    v_cvt_pk_bf16_f32 v90, v60, v61
    v_cvt_pk_bf16_f32 v91, v62, v63
    s_nop 0
    v_permlane16_swap_b32 v88, v90
    v_permlane16_swap_b32 v89, v91
    buffer_store_dwordx4 v[88:91], v4, s[16:19], s25 offen offset:256 sc1
    v_add_u32 v10, 0x1c000, v10
    s_add_u32 m0, s81, 0
    s_nop 0
    buffer_load_dwordx4 v10, s[28:31], 0 offen offset:0 lds
    buffer_load_dwordx4 v10, s[28:31], s82 offen offset:1024 lds
    s_waitcnt vmcnt(17)
    ds_read_b64_tr_b16 a[160:161], v17 offset:5120
    ds_read_b64_tr_b16 a[162:163], v17 offset:5376
    s_waitcnt vmcnt(16)
    ds_read_b64_tr_b16 a[164:165], v17 offset:6144
    ds_read_b64_tr_b16 a[166:167], v17 offset:6400
    s_waitcnt vmcnt(15)
    ds_read_b64_tr_b16 a[168:169], v17 offset:7168
    ds_read_b64_tr_b16 a[170:171], v17 offset:7424
    s_waitcnt vmcnt(14)
    ds_read_b64_tr_b16 a[172:173], v17 offset:8192
    ds_read_b64_tr_b16 a[174:175], v17 offset:8448
    s_waitcnt vmcnt(13)
    ds_read_b64_tr_b16 a[64:65], v17 offset:9216
    ds_read_b64_tr_b16 a[66:67], v17 offset:9472
    s_waitcnt vmcnt(12)
    ds_read_b64_tr_b16 a[68:69], v17 offset:10240
    ds_read_b64_tr_b16 a[70:71], v17 offset:10496
    s_waitcnt vmcnt(11)
    ds_read_b64_tr_b16 a[72:73], v17 offset:11264
    ds_read_b64_tr_b16 a[74:75], v17 offset:11520
    s_waitcnt vmcnt(10)
    ds_read_b64_tr_b16 a[76:77], v17 offset:12288
    ds_read_b64_tr_b16 a[78:79], v17 offset:12544
    s_waitcnt vmcnt(9)
    ds_read_b64_tr_b16 a[176:177], v17 offset:13312
    ds_read_b64_tr_b16 a[178:179], v17 offset:13568
    s_waitcnt vmcnt(8)
    ds_read_b64_tr_b16 a[180:181], v17 offset:0
    ds_read_b64_tr_b16 a[182:183], v17 offset:256
    s_waitcnt vmcnt(3)
    v_cmp_ne_u64 vcc, s[46:47], v[98:99]
    s_cbranch_vccnz retry_14
back_15:
    s_barrier
    s_add_u32 m0, s65, 0
    s_add_u32 s79, s4, 0
    buffer_load_dwordx4 v3, s[16:19], s79 offen sc1 lds
    s_add_u32 m0, s65, 1024
    s_add_u32 s79, s4, 135168
    buffer_load_dwordx4 v3, s[16:19], s79 offen sc1 lds
    s_add_u32 m0, s65, 2048
    s_add_u32 s79, s4, 270336
    buffer_load_dwordx4 v3, s[16:19], s79 offen sc1 lds
    s_add_u32 m0, s65, 3072
    s_add_u32 s79, s4, 405504
    buffer_load_dwordx4 v3, s[16:19], s79 offen sc1 lds
    s_add_u32 m0, s65, 4096
    s_add_u32 s79, s4, 540672
    buffer_load_dwordx4 v3, s[16:19], s79 offen sc1 lds
    s_add_u32 m0, s65, 5120
    s_add_u32 s79, s4, 675840
    buffer_load_dwordx4 v3, s[16:19], s79 offen sc1 lds
    s_add_u32 m0, s65, 6144
    s_add_u32 s79, s4, 811008
    buffer_load_dwordx4 v3, s[16:19], s79 offen sc1 lds
    v_add_u32 v10, 0xfffe4000, v10
    s_add_u32 m0, s81, 2048
    s_nop 0
    buffer_load_dwordx4 v10, s[32:35], 0 offen offset:0 lds
    buffer_load_dwordx4 v10, s[32:35], s82 offen offset:1024 lds
    buffer_load_dwordx4 v10, s[32:35], s83 offen offset:2048 lds
    buffer_load_dwordx4 v10, s[32:35], s84 offen offset:3072 lds
    v_add_u32 v10, 0x38000, v10
    s_add_u32 m0, s81, 6144
    s_nop 0
    buffer_load_dwordx4 v10, s[28:31], 0 offen offset:0 lds
    buffer_load_dwordx4 v10, s[28:31], s82 offen offset:1024 lds
    ds_read_b64_tr_b16 a[184:185], v17 offset:1024
    ds_read_b64_tr_b16 a[186:187], v17 offset:1280
    ds_read_b64_tr_b16 a[188:189], v17 offset:2048
    ds_read_b64_tr_b16 a[190:191], v17 offset:2304
    ds_read_b64_tr_b16 a[80:81], v17 offset:3072
    ds_read_b64_tr_b16 a[82:83], v17 offset:3328
    ds_read_b64_tr_b16 a[84:85], v17 offset:4096
    ds_read_b64_tr_b16 a[86:87], v17 offset:4352
    s_and_b32 s23, s49, 1
    v_min_u32 v26, 96, v24
    v_lshlrev_b32 v26, 10, v26
    s_lshl_b32 s20, s54, 11
    s_add_u32 s20, s20, 32768
    s_and_b32 s60, s49, 6
    s_add_u32 s60, s60, s62
    s_lshl_b32 s60, s60, 2
    s_add_u32 s60, s60, s50
    s_lshl_b32 s64, s60, 9
    s_add_u32 s64, s64, 196608
    s_mul_i32 s11, s60, 33280
    s_lshl_b32 s60, s23, 1
    s_add_u32 s60, s60, s63
    s_lshl_b32 s60, s60, 11
    s_add_u32 s11, s11, s60
    s_add_u32 s11, s11, 4177920
    s_lshl_b32 s25, s55, 2
    s_add_u32 s25, s25, s48
    s_lshl_b32 s25, s25, 9
    s_add_u32 s25, s25, 65536
    v_bfe_u32 v5, v0, 5, 1
    v_mul_u32_u24 v30, 28160, v5
    v_add_u32 v30, v30, v24
    v_lshlrev_b32 v22, 8, v5
    v_bfe_u32 v5, v0, 4, 1
    v_lshl_add_u32 v22, v5, 12, v22
    v_and_b32 v5, 15, v0
    v_bfe_u32 v6, v0, 4, 2
    v_lshlrev_b32 v25, 4, v5
    v_add_u32 v22, v22, v25
    v_mul_u32_u24 v8, 272, v5
    s_mul_i32 s61, s48, 4352
    v_lshl_add_u32 v6, v6, 4, s61
    v_add_u32 v8, v8, v6
    v_lshrrev_b32 v6, 4, v0
    s_lshl_b32 s61, s23, 6
    v_lshl_add_u32 v9, v6, 2, s61
    v_mul_u32_u24 v28, 272, v6
    v_add_u32 v28, v28, v25
    s_waitcnt vmcnt(6)
    s_barrier
    s_cmp_lg_u32 s48, 0
    s_cbranch_scc1 noflag_16
    buffer_store_dwordx4 v[12:15], v27, s[16:19], s89 offen offset:0 sc1
noflag_16:
    ds_read_b64_tr_b16 v[32:33], v11 offset:0
    ds_read_b64_tr_b16 v[34:35], v11 offset:256
    ds_read_b64_tr_b16 v[36:37], v11 offset:14336
    ds_read_b64_tr_b16 v[38:39], v11 offset:14592
    ds_read_b64_tr_b16 v[40:41], v11 offset:1024
    ds_read_b64_tr_b16 v[42:43], v11 offset:1280
    s_waitcnt lgkmcnt(4)
    v_mfma_f32_32x32x16_bf16 v[64:79], a[0:3], v[32:35], 0
    ds_read_b64_tr_b16 v[44:45], v11 offset:15360
    v_bfe_u32 v7, v0, 4, 2
    s_add_u32 m0, s65, 28672
    s_add_u32 s79, s4, 1892352
    buffer_load_dwordx4 v3, s[16:19], s79 offen sc1 lds
    v_mfma_f32_32x32x16_bf16 v[80:95], a[112:115], v[32:35], 0
    ds_read_b64_tr_b16 v[46:47], v11 offset:15616
    v_lshl_add_u32 v16, v7, 2, v25
    ds_read_b64_tr_b16 a[88:89], v18 offset:0
    ds_read_b64_tr_b16 a[90:91], v18 offset:256
    v_and_b32 v29, 3, v0
    s_waitcnt lgkmcnt(6)
    v_mfma_f32_32x32x16_bf16 v[96:111], a[0:3], v[36:39], 0
    ds_read_b64_tr_b16 v[32:33], v11 offset:2048
    v_lshl_add_u32 v29, v7, 2, v29
    s_add_u32 m0, s65, 29696
    s_add_u32 s79, s4, 2027520
    buffer_load_dwordx4 v3, s[16:19], s79 offen sc1 lds
    v_mfma_f32_32x32x16_bf16 v[112:127], a[112:115], v[36:39], 0
    ds_read_b64_tr_b16 v[34:35], v11 offset:2304
    v_bfe_u32 v7, v0, 2, 2
    ds_read_b64_tr_b16 a[92:93], v18 offset:1024
    ds_read_b64_tr_b16 a[94:95], v18 offset:1280
    v_lshl_add_u32 v29, v29, 2, v7
    s_waitcnt lgkmcnt(8)
    v_mfma_f32_32x32x16_bf16 v[64:79], a[4:7], v[40:43], v[64:79]
    ds_read_b64_tr_b16 v[36:37], v11 offset:16384
    s_lshl2_add_u32 s61, s23, s48
    s_lshl_b32 s61, s61, 3
    s_add_u32 m0, s65, 30720
    s_add_u32 s79, s4, 2162688
    buffer_load_dwordx4 v3, s[16:19], s79 offen sc1 lds
    v_mfma_f32_32x32x16_bf16 v[80:95], a[116:119], v[40:43], v[80:95]
    ds_read_b64_tr_b16 v[38:39], v11 offset:16640
    s_lshl_b32 s60, s51, 12
    s_add_u32 s61, s61, s60
    v_lshl_add_u32 v29, v29, 6, s61
    v_mov_b32 v7, 14336
    s_waitcnt lgkmcnt(8)
    v_mfma_f32_32x32x16_bf16 v[96:111], a[4:7], v[44:47], v[96:111]
    ds_read_b64_tr_b16 v[40:41], v11 offset:3072
    v_cmp_ge_u32 s[70:71], v29, v7
    s_nop 1
    v_cndmask_b32 v7, 0, v7, s[70:71]
    v_mfma_f32_32x32x16_bf16 v[112:127], a[116:119], v[44:47], v[112:127]
    ds_read_b64_tr_b16 v[42:43], v11 offset:3328
    s_add_u32 m0, s65, 31744
    s_add_u32 s79, s4, 2297856
    buffer_load_dwordx4 v3, s[16:19], s79 offen sc1 lds
    v_add_u32 v23, v29, v7
    s_waitcnt lgkmcnt(6)
    v_mfma_f32_32x32x16_bf16 v[64:79], a[8:11], v[32:35], v[64:79]
    ds_read_b64_tr_b16 v[44:45], v11 offset:17408
    v_mul_u32_u24 v31, 896, v6
    v_lshl_add_u32 v31, v5, 3, v31
    v_bfe_u32 v5, v0, 5, 1
    v_mul_u32_u24 v5, 1792, v5
    v_mfma_f32_32x32x16_bf16 v[80:95], a[120:123], v[32:35], v[80:95]
    ds_read_b64_tr_b16 v[46:47], v11 offset:17664
    s_add_u32 m0, s65, 32768
    s_add_u32 s79, s4, 2433024
    buffer_load_dwordx4 v3, s[16:19], s79 offen sc1 lds
    v_sub_u32 v25, v25, v5
    s_waitcnt lgkmcnt(4)
    v_mfma_f32_32x32x16_bf16 v[96:111], a[8:11], v[36:39], v[96:111]
    ds_read_b64_tr_b16 v[32:33], v11 offset:4096
    v_add_u32 v25, 1792, v25
    s_lshl_b32 s61, s54, 1
    s_add_u32 s61, s61, s23
    s_mul_i32 s24, s61, 14336
    v_mfma_f32_32x32x16_bf16 v[112:127], a[120:123], v[36:39], v[112:127]
    ds_read_b64_tr_b16 v[34:35], v11 offset:4352
    s_lshl_b32 s61, s51, 7
    s_add_u32 s24, s24, s61
    s_lshl_b32 s68, s51, 8
    s_add_u32 m0, s65, 33792
    s_add_u32 s79, s4, 2568192
    buffer_load_dwordx4 v3, s[16:19], s79 offen sc1 lds
    s_waitcnt lgkmcnt(4)
    v_mfma_f32_32x32x16_bf16 v[64:79], a[12:15], v[40:43], v[64:79]
    ds_read_b64_tr_b16 v[36:37], v11 offset:18432
    s_add_u32 s68, s68, 27648
    v_mfma_f32_32x32x16_bf16 v[80:95], a[124:127], v[40:43], v[80:95]
    ds_read_b64_tr_b16 v[38:39], v11 offset:18688
    s_waitcnt lgkmcnt(4)
    v_mfma_f32_32x32x16_bf16 v[96:111], a[12:15], v[44:47], v[96:111]
    ds_read_b64_tr_b16 v[40:41], v11 offset:5120
    s_add_u32 m0, s65, 34816
    s_add_u32 s79, s4, 2703360
    buffer_load_dwordx4 v3, s[16:19], s79 offen sc1 lds
    v_mfma_f32_32x32x16_bf16 v[112:127], a[124:127], v[44:47], v[112:127]
    ds_read_b64_tr_b16 v[42:43], v11 offset:5376
    s_waitcnt lgkmcnt(4)
    v_mfma_f32_32x32x16_bf16 v[64:79], a[16:19], v[32:35], v[64:79]
    ds_read_b64_tr_b16 v[44:45], v11 offset:19456
    v_add_u32 v10, 0x1c000, v10
    s_add_u32 m0, s81, 8192
    s_nop 0
    buffer_load_dwordx4 v10, s[28:31], 0 offen offset:0 lds
    v_mfma_f32_32x32x16_bf16 v[80:95], a[128:131], v[32:35], v[80:95]
    ds_read_b64_tr_b16 v[46:47], v11 offset:19712
    s_waitcnt lgkmcnt(4)
    v_mfma_f32_32x32x16_bf16 v[96:111], a[16:19], v[36:39], v[96:111]
    ds_read_b64_tr_b16 v[32:33], v11 offset:6144
    v_mfma_f32_32x32x16_bf16 v[112:127], a[128:131], v[36:39], v[112:127]
    ds_read_b64_tr_b16 v[34:35], v11 offset:6400
    buffer_load_dwordx4 v10, s[28:31], s82 offen offset:1024 lds
    s_waitcnt vmcnt(14)
    ds_read_b64_tr_b16 a[192:193], v18 offset:2048
    ds_read_b64_tr_b16 a[194:195], v18 offset:2304
    s_waitcnt lgkmcnt(6)
    v_mfma_f32_32x32x16_bf16 v[64:79], a[20:23], v[40:43], v[64:79]
    ds_read_b64_tr_b16 v[36:37], v11 offset:20480
    s_waitcnt vmcnt(13)
    ds_read_b64_tr_b16 a[196:197], v18 offset:3072
    ds_read_b64_tr_b16 a[198:199], v18 offset:3328
    v_mfma_f32_32x32x16_bf16 v[80:95], a[132:135], v[40:43], v[80:95]
    ds_read_b64_tr_b16 v[38:39], v11 offset:20736
    buffer_load_dwordx4 v[48:51], v30, s[16:19], s25 offen sc1
    s_waitcnt vmcnt(13)
    ds_read_b64_tr_b16 a[200:201], v18 offset:4096
    ds_read_b64_tr_b16 a[202:203], v18 offset:4352
    s_waitcnt lgkmcnt(10)
    v_mfma_f32_32x32x16_bf16 v[96:111], a[20:23], v[44:47], v[96:111]
    ds_read_b64_tr_b16 v[40:41], v11 offset:7168
    s_waitcnt vmcnt(12)
    ds_read_b64_tr_b16 a[204:205], v18 offset:5120
    ds_read_b64_tr_b16 a[206:207], v18 offset:5376
    v_mfma_f32_32x32x16_bf16 v[112:127], a[132:135], v[44:47], v[112:127]
    ds_read_b64_tr_b16 v[42:43], v11 offset:7424
    v_add_u32 v10, 0xfffe4000, v10
    s_add_u32 m0, s80, 62464
    s_nop 0
    buffer_load_dwordx4 v10, s[32:35], 0 offen offset:0 lds
    s_waitcnt lgkmcnt(12)
    v_mfma_f32_32x32x16_bf16 v[64:79], a[24:27], v[32:35], v[64:79]
    ds_read_b64_tr_b16 v[44:45], v11 offset:21504
    s_waitcnt vmcnt(12)
    ds_read_b64_tr_b16 a[96:97], v18 offset:6144
    ds_read_b64_tr_b16 a[98:99], v18 offset:6400
    v_mfma_f32_32x32x16_bf16 v[80:95], a[136:139], v[32:35], v[80:95]
    ds_read_b64_tr_b16 v[46:47], v11 offset:21760
    s_waitcnt vmcnt(11)
    ds_read_b64_tr_b16 a[100:101], v18 offset:7168
    ds_read_b64_tr_b16 a[102:103], v18 offset:7424
    buffer_load_dwordx4 v10, s[32:35], s82 offen offset:1024 lds
    s_waitcnt lgkmcnt(12)
    v_mfma_f32_32x32x16_bf16 v[96:111], a[24:27], v[36:39], v[96:111]
    ds_read_b64_tr_b16 v[32:33], v11 offset:8192
    v_mfma_f32_32x32x16_bf16 v[112:127], a[136:139], v[36:39], v[112:127]
    ds_read_b64_tr_b16 v[34:35], v11 offset:8448
    s_waitcnt lgkmcnt(8)
    v_mfma_f32_32x32x16_bf16 v[64:79], a[28:31], v[40:43], v[64:79]
    ds_read_b64_tr_b16 v[36:37], v11 offset:22528
    buffer_load_dwordx4 v10, s[32:35], s83 offen offset:2048 lds
    v_mfma_f32_32x32x16_bf16 v[80:95], a[140:143], v[40:43], v[80:95]
    ds_read_b64_tr_b16 v[38:39], v11 offset:22784
    s_waitcnt lgkmcnt(6)
    v_mfma_f32_32x32x16_bf16 v[96:111], a[28:31], v[44:47], v[96:111]
    ds_read_b64_tr_b16 v[40:41], v11 offset:9216
    ds_read_b64_tr_b16 v[128:129], v23 offset:0
    buffer_load_dwordx4 v[52:55], v2, s[16:19], s88 offen sc1
    ds_read_b64_tr_b16 v[130:131], v23 offset:14336
    v_mfma_f32_32x32x16_bf16 v[112:127], a[140:143], v[44:47], v[112:127]
    ds_read_b64_tr_b16 v[42:43], v11 offset:9472
    s_waitcnt lgkmcnt(6)
    v_mfma_f32_32x32x16_bf16 v[64:79], a[32:35], v[32:35], v[64:79]
    ds_read_b64_tr_b16 v[44:45], v11 offset:23552
    v_mfma_f32_32x32x16_bf16 v[80:95], a[144:147], v[32:35], v[80:95]
    ds_read_b64_tr_b16 v[46:47], v11 offset:23808
    buffer_load_dwordx4 v10, s[32:35], s84 offen offset:3072 lds
    s_waitcnt lgkmcnt(6)
    v_mfma_f32_32x32x16_bf16 v[96:111], a[32:35], v[36:39], v[96:111]
    ds_read_b64_tr_b16 v[32:33], v11 offset:10240
    v_mfma_f32_32x32x16_bf16 v[112:127], a[144:147], v[36:39], v[112:127]
    ds_read_b64_tr_b16 v[34:35], v11 offset:10496
    s_add_u32 m0, s80, 67584
    s_nop 0
    buffer_load_dwordx4 v19, s[36:39], 0 offen offset:0 lds
    s_waitcnt lgkmcnt(4)
    v_mfma_f32_32x32x16_bf16 v[64:79], a[36:39], v[40:43], v[64:79]
    ds_read_b64_tr_b16 v[36:37], v11 offset:24576
    v_mfma_f32_32x32x16_bf16 v[80:95], a[148:151], v[40:43], v[80:95]
    ds_read_b64_tr_b16 v[38:39], v11 offset:24832
    s_waitcnt lgkmcnt(4)
    v_mfma_f32_32x32x16_bf16 v[96:111], a[36:39], v[44:47], v[96:111]
    ds_read_b64_tr_b16 v[40:41], v11 offset:11264
    buffer_load_dwordx4 v19, s[36:39], s85 offen offset:1024 lds
    v_mfma_f32_32x32x16_bf16 v[112:127], a[148:151], v[44:47], v[112:127]
    ds_read_b64_tr_b16 v[42:43], v11 offset:11520
    s_waitcnt lgkmcnt(4)
    v_mfma_f32_32x32x16_bf16 v[64:79], a[40:43], v[32:35], v[64:79]
    ds_read_b64_tr_b16 v[44:45], v11 offset:25600
    buffer_load_dwordx4 v19, s[36:39], s86 offen offset:2048 lds
    v_mfma_f32_32x32x16_bf16 v[80:95], a[152:155], v[32:35], v[80:95]
    ds_read_b64_tr_b16 v[46:47], v11 offset:25856
    s_waitcnt lgkmcnt(4)
    v_mfma_f32_32x32x16_bf16 v[96:111], a[40:43], v[36:39], v[96:111]
    ds_read_b64_tr_b16 v[32:33], v11 offset:12288
    buffer_load_dwordx4 v19, s[36:39], s87 offen offset:3072 lds
    v_mfma_f32_32x32x16_bf16 v[112:127], a[152:155], v[36:39], v[112:127]
    ds_read_b64_tr_b16 v[34:35], v11 offset:12544
    s_waitcnt lgkmcnt(4)
    v_mfma_f32_32x32x16_bf16 v[64:79], a[44:47], v[40:43], v[64:79]
    ds_read_b64_tr_b16 v[36:37], v11 offset:26624
    v_mfma_f32_32x32x16_bf16 v[80:95], a[156:159], v[40:43], v[80:95]
    ds_read_b64_tr_b16 v[38:39], v11 offset:26880
    v_add_u32 v19, 0x7000, v19
    s_add_u32 m0, s80, 57344
    s_nop 0
    buffer_load_dwordx4 v19, s[36:39], 0 offen offset:0 lds
    s_waitcnt lgkmcnt(4)
    v_mfma_f32_32x32x16_bf16 v[96:111], a[44:47], v[44:47], v[96:111]
    ds_read_b64_tr_b16 v[40:41], v11 offset:13312
    s_waitcnt vmcnt(12)
    ds_read_b64_tr_b16 a[104:105], v18 offset:8192
    ds_read_b64_tr_b16 a[106:107], v18 offset:8448
    v_mfma_f32_32x32x16_bf16 v[112:127], a[156:159], v[44:47], v[112:127]
    ds_read_b64_tr_b16 v[42:43], v11 offset:13568
    buffer_load_dwordx4 v19, s[36:39], s85 offen offset:1024 lds
    s_waitcnt lgkmcnt(6)
    v_mfma_f32_32x32x16_bf16 v[64:79], a[48:51], v[32:35], v[64:79]
    ds_read_b64_tr_b16 v[44:45], v11 offset:27648
    s_waitcnt vmcnt(12)
    ds_read_b64_tr_b16 a[108:109], v18 offset:9216
    ds_read_b64_tr_b16 a[110:111], v18 offset:9472
    v_mfma_f32_32x32x16_bf16 v[80:95], a[160:163], v[32:35], v[80:95]
    ds_read_b64_tr_b16 v[46:47], v11 offset:27904
    s_waitcnt lgkmcnt(8)
    v_mfma_f32_32x32x16_bf16 v[96:111], a[48:51], v[36:39], v[96:111]
    s_waitcnt lgkmcnt(0)
    s_barrier
    ds_read_b64_tr_b16 v[32:33], v11 offset:28672
    buffer_load_dwordx4 v19, s[36:39], s86 offen offset:2048 lds
    v_mfma_f32_32x32x16_bf16 v[112:127], a[160:163], v[36:39], v[112:127]
    ds_read_b64_tr_b16 v[34:35], v11 offset:28928
    v_mfma_f32_32x32x16_bf16 v[64:79], a[52:55], v[40:43], v[64:79]
    ds_read_b64_tr_b16 v[36:37], v11 offset:29696
    s_waitcnt vmcnt(8)
    v_cmp_ne_u64 vcc, s[46:47], v[54:55]
    s_cbranch_vccnz retry_17
back_18:
    buffer_load_dwordx4 v19, s[36:39], s87 offen offset:3072 lds
    v_mfma_f32_32x32x16_bf16 v[80:95], a[164:167], v[40:43], v[80:95]
    ds_read_b64_tr_b16 v[38:39], v11 offset:29952
    ds_read_b64_tr_b16 a[208:209], v17 offset:5120
    ds_read_b64_tr_b16 a[210:211], v17 offset:5376
    ds_read_b64_tr_b16 a[212:213], v17 offset:6144
    ds_read_b64_tr_b16 a[214:215], v17 offset:6400
    v_mfma_f32_32x32x16_bf16 v[96:111], a[52:55], v[44:47], v[96:111]
    ds_read_b64_tr_b16 v[40:41], v11 offset:30720
    s_add_u32 m0, s65, 0
    s_add_u32 s79, s5, 256
    buffer_load_dwordx4 v3, s[16:19], s79 offen sc1 lds
    v_mfma_f32_32x32x16_bf16 v[112:127], a[164:167], v[44:47], v[112:127]
    ds_read_b64_tr_b16 v[42:43], v11 offset:30976
    ds_read_b64_tr_b16 a[216:217], v17 offset:7168
    ds_read_b64_tr_b16 a[218:219], v17 offset:7424
    s_waitcnt lgkmcnt(10)
    v_mfma_f32_32x32x16_bf16 v[64:79], a[56:59], v[32:35], v[64:79]
    ds_read_b64_tr_b16 v[44:45], v11 offset:31744
    v_mfma_f32_32x32x16_bf16 v[80:95], a[168:171], v[32:35], v[80:95]
    ds_read_b64_tr_b16 v[46:47], v11 offset:32000
    s_add_u32 m0, s65, 1024
    s_add_u32 s79, s5, 135424
    buffer_load_dwordx4 v3, s[16:19], s79 offen sc1 lds
    s_waitcnt lgkmcnt(10)
    v_mfma_f32_32x32x16_bf16 v[64:79], a[60:63], v[36:39], v[64:79]
    ds_read_b64_tr_b16 v[32:33], v11 offset:32768
    v_mfma_f32_32x32x16_bf16 v[80:95], a[172:175], v[36:39], v[80:95]
    ds_read_b64_tr_b16 v[34:35], v11 offset:33024
    s_add_u32 m0, s65, 2048
    s_add_u32 s79, s5, 270592
    buffer_load_dwordx4 v3, s[16:19], s79 offen sc1 lds
    s_waitcnt lgkmcnt(6)
    v_mfma_f32_32x32x16_bf16 v[64:79], a[64:67], v[40:43], v[64:79]
    ds_read_b64_tr_b16 v[36:37], v11 offset:33792
    ds_read_b64_tr_b16 v[132:133], v23 offset:0
    ds_read_b64_tr_b16 v[134:135], v23 offset:14336
    v_mfma_f32_32x32x16_bf16 v[80:95], a[176:179], v[40:43], v[80:95]
    ds_read_b64_tr_b16 v[38:39], v11 offset:34048
    buffer_load_dwordx4 v[4:7], v24, s[16:19], s20 offen offset:0 sc1
    s_waitcnt lgkmcnt(6)
    v_mfma_f32_32x32x16_bf16 v[64:79], a[68:71], v[44:47], v[64:79]
    ds_read_b64_tr_b16 v[40:41], v11 offset:34816
    s_waitcnt vmcnt(12)
    ds_read_b64_tr_b16 a[220:221], v17 offset:8192
    ds_read_b64_tr_b16 a[222:223], v17 offset:8448
    v_mfma_f32_32x32x16_bf16 v[80:95], a[180:183], v[44:47], v[80:95]
    ds_read_b64_tr_b16 v[42:43], v11 offset:35072
    s_add_u32 m0, s65, 3072
    s_add_u32 s79, s5, 405760
    buffer_load_dwordx4 v3, s[16:19], s79 offen sc1 lds
    s_waitcnt lgkmcnt(8)
    v_mfma_f32_32x32x16_bf16 v[64:79], a[72:75], v[32:35], v[64:79]
    ds_read_b64_tr_b16 v[44:45], v11 offset:35840
    v_cmp_ne_u64 vcc, s[46:47], v[50:51]
    s_cbranch_vccnz retry_19
back_20:
    v_mov_b32 v56, v48
    v_mov_b32 v58, 0
    v_mfma_f32_32x32x16_bf16 v[80:95], a[184:187], v[32:35], v[80:95]
    ds_read_b64_tr_b16 v[46:47], v11 offset:36096
    v_mov_b32 v60, 0
    v_mov_b32 v62, v48
    v_mov_b32 v57, v49
    v_mov_b32 v59, 0
    s_waitcnt lgkmcnt(6)
    v_mfma_f32_32x32x16_bf16 v[64:79], a[76:79], v[36:39], v[64:79]
    ds_read_b64_tr_b16 v[32:33], v11 offset:36864
    s_add_u32 m0, s65, 4096
    s_add_u32 s79, s5, 540928
    buffer_load_dwordx4 v3, s[16:19], s79 offen sc1 lds
    v_mov_b32 v61, 0
    v_mfma_f32_32x32x16_bf16 v[80:95], a[188:191], v[36:39], v[80:95]
    ds_read_b64_tr_b16 v[34:35], v11 offset:37120
    v_mov_b32 v63, v49
    v_permlane32_swap_b32 v56, v58
    v_permlane32_swap_b32 v60, v62
    v_permlane32_swap_b32 v57, v59
    s_waitcnt lgkmcnt(4)
    v_mfma_f32_32x32x16_bf16 v[64:79], a[80:83], v[40:43], v[64:79]
    ds_read_b64_tr_b16 v[36:37], v11 offset:37888
    v_permlane32_swap_b32 v61, v63
    s_add_u32 m0, s65, 5120
    s_add_u32 s79, s5, 676096
    buffer_load_dwordx4 v3, s[16:19], s79 offen sc1 lds
    v_mfma_f32_32x32x16_bf16 v[80:95], a[192:195], v[40:43], v[80:95]
    ds_read_b64_tr_b16 v[38:39], v11 offset:38144
    s_waitcnt lgkmcnt(4)
    v_mfma_f32_32x32x16_bf16 v[64:79], a[84:87], v[44:47], v[64:79]
    ds_read_b64_tr_b16 v[40:41], v11 offset:38912
    s_waitcnt vmcnt(13)
    ds_read_b64_tr_b16 v[160:161], v20 offset:10240
    ds_read_b64_tr_b16 v[164:165], v20 offset:10272
    v_mfma_f32_32x32x16_bf16 v[80:95], a[196:199], v[44:47], v[80:95]
    ds_read_b64_tr_b16 v[42:43], v11 offset:39168
    s_add_u32 m0, s65, 6144
    s_add_u32 s79, s5, 811264
    buffer_load_dwordx4 v3, s[16:19], s79 offen sc1 lds
    s_waitcnt lgkmcnt(6)
    v_mfma_f32_32x32x16_bf16 v[64:79], a[88:91], v[32:35], v[64:79]
    ds_read_b64_tr_b16 v[44:45], v11 offset:39936
    ds_read_b64_tr_b16 v[168:169], v20 offset:10752
    ds_read_b64_tr_b16 v[172:173], v20 offset:10784
    v_mfma_f32_32x32x16_bf16 v[80:95], a[200:203], v[32:35], v[80:95]
    ds_read_b64_tr_b16 v[46:47], v11 offset:40192
    v_add_u32 v19, 0x15000, v19
    s_add_u32 m0, s80, 61440
    s_nop 0
    buffer_load_dwordx4 v19, s[36:39], 0 offen offset:0 lds
    s_waitcnt lgkmcnt(8)
    v_mfma_f32_32x32x16_bf16 v[64:79], a[92:95], v[36:39], v[64:79]
    ds_read_b64_tr_b16 v[32:33], v11 offset:40960
    s_waitcnt vmcnt(13)
    ds_read_b64_tr_b16 v[162:163], v20 offset:12288
    ds_read_b64_tr_b16 v[166:167], v20 offset:12320
    v_mfma_f32_32x32x16_bf16 v[80:95], a[204:207], v[36:39], v[80:95]
    ds_read_b64_tr_b16 v[34:35], v11 offset:41216
    ds_read_b64_tr_b16 v[170:171], v20 offset:12800
    ds_read_b64_tr_b16 v[174:175], v20 offset:12832
    buffer_load_dwordx4 v19, s[36:39], s85 offen offset:1024 lds
    s_waitcnt lgkmcnt(10)
    v_mfma_f32_32x32x16_bf16 v[64:79], a[96:99], v[40:43], v[64:79]
    ds_read_b64_tr_b16 v[36:37], v11 offset:41984
    v_mfma_f32_32x32x16_bf16 v[80:95], a[208:211], v[40:43], v[80:95]
    ds_read_b64_tr_b16 v[38:39], v11 offset:42240
    s_waitcnt lgkmcnt(8)
    v_mfma_f32_32x32x16_bf16 v[64:79], a[100:103], v[44:47], v[64:79]
    ds_read_b64_tr_b16 v[40:41], v11 offset:43008
    v_add_u32 v19, 0x1c00, v19
    s_add_u32 m0, s81, 0
    s_nop 0
    buffer_load_dwordx4 v19, s[36:39], 0 offen offset:0 lds
    v_mfma_f32_32x32x16_bf16 v[80:95], a[212:215], v[44:47], v[80:95]
    ds_read_b64_tr_b16 v[42:43], v11 offset:43264
    s_waitcnt vmcnt(13)
    ds_read_b64_tr_b16 v[176:177], v20 offset:0
    ds_read_b64_tr_b16 v[180:181], v20 offset:32
    s_waitcnt lgkmcnt(8)
    v_mfma_f32_32x32x16_bf16 v[64:79], a[104:107], v[32:35], v[64:79]
    ds_read_b64_tr_b16 v[44:45], v11 offset:44032
    buffer_load_dwordx4 v19, s[36:39], s85 offen offset:1024 lds
    ds_read_b64_tr_b16 v[184:185], v20 offset:512
    ds_read_b64_tr_b16 v[188:189], v20 offset:544
    v_mfma_f32_32x32x16_bf16 v[80:95], a[216:219], v[32:35], v[80:95]
    ds_read_b64_tr_b16 v[46:47], v11 offset:44288
    s_waitcnt lgkmcnt(8)
    v_mfma_f32_32x32x16_bf16 v[64:79], a[108:111], v[36:39], v[64:79]
    ds_read_b64_tr_b16 v[32:33], v11 offset:45056
    v_mfma_f32_32x32x16_bf16 v[80:95], a[220:223], v[36:39], v[80:95]
    ds_read_b64_tr_b16 v[34:35], v11 offset:45312
    v_add_u32 v19, 0x5400, v19
    s_add_u32 m0, s81, 2048
    s_nop 0
    buffer_load_dwordx4 v19, s[36:39], 0 offen offset:0 lds
    s_waitcnt lgkmcnt(8)
    v_mfma_f32_32x32x16_bf16 v[96:111], a[56:59], v[40:43], v[96:111]
    ds_read_b64_tr_b16 v[36:37], v11 offset:46080
    s_waitcnt vmcnt(13)
    ds_read_b64_tr_b16 v[178:179], v20 offset:2048
    ds_read_b64_tr_b16 v[182:183], v20 offset:2080
    v_mfma_f32_32x32x16_bf16 v[112:127], a[168:171], v[40:43], v[112:127]
    ds_read_b64_tr_b16 v[38:39], v11 offset:46336
    buffer_load_dwordx4 v19, s[36:39], s85 offen offset:1024 lds
    ds_read_b64_tr_b16 v[186:187], v20 offset:2560
    ds_read_b64_tr_b16 v[190:191], v20 offset:2592
    s_waitcnt lgkmcnt(8)
    v_mfma_f32_32x32x16_bf16 v[96:111], a[60:63], v[44:47], v[96:111]
    ds_read_b64_tr_b16 v[40:41], v11 offset:47104
    s_waitcnt vmcnt(10)
    v_cmp_ne_u64 vcc, s[46:47], v[6:7]
    s_cbranch_vccnz retry_21
back_22:
    v_mov_b32 v6, v5
    v_mov_b32 v5, v4
    v_mfma_f32_32x32x16_bf16 v[112:127], a[172:175], v[44:47], v[112:127]
    ds_read_b64_tr_b16 v[42:43], v11 offset:47360
    v_mfma_f32_32x32x8_bf16 v[64:79], v[56:57], v[4:5], v[64:79]
    v_mfma_f32_32x32x8_bf16 v[80:95], v[58:59], v[4:5], v[80:95]
    ds_bpermute_b32 v12, v9, v6 offset:0
    buffer_load_dwordx4 v19, s[36:39], s86 offen offset:2048 lds
    s_waitcnt lgkmcnt(9)
    v_mfma_f32_32x32x16_bf16 v[96:111], a[64:67], v[32:35], v[96:111]
    ds_read_b64_tr_b16 v[44:45], v11 offset:48128
    buffer_load_dwordx4 v19, s[36:39], s87 offen offset:3072 lds
    v_mfma_f32_32x32x16_bf16 v[112:127], a[176:179], v[32:35], v[112:127]
    ds_read_b64_tr_b16 v[46:47], v11 offset:48384
    s_waitcnt lgkmcnt(7)
    v_mfma_f32_32x32x16_bf16 v[96:111], a[68:71], v[36:39], v[96:111]
    ds_read_b64_tr_b16 v[32:33], v11 offset:49152
    v_max_f32 v64, 0, v64
    v_add_u32 v19, 0x15000, v19
    s_add_u32 m0, s81, 6144
    s_nop 0
    buffer_load_dwordx4 v19, s[36:39], 0 offen offset:0 lds
    v_mfma_f32_32x32x16_bf16 v[112:127], a[180:183], v[36:39], v[112:127]
    ds_read_b64_tr_b16 v[34:35], v11 offset:49408
    v_mul_f32 v64, v64, v80
    v_max_f32 v65, 0, v65
    v_mul_f32 v65, v65, v81
    v_cvt_pk_bf16_f32 v48, v64, v65
    s_waitcnt lgkmcnt(5)
    v_mfma_f32_32x32x16_bf16 v[96:111], a[72:75], v[40:43], v[96:111]
    ds_read_b64_tr_b16 v[36:37], v11 offset:50176
    v_max_f32 v66, 0, v66
    buffer_load_dwordx4 v19, s[36:39], s85 offen offset:1024 lds
    v_mul_f32 v66, v66, v82
    v_max_f32 v67, 0, v67
    v_mfma_f32_32x32x16_bf16 v[112:127], a[184:187], v[40:43], v[112:127]
    ds_read_b64_tr_b16 v[38:39], v11 offset:50432
    v_mul_f32 v67, v67, v83
    v_cvt_pk_bf16_f32 v49, v66, v67
    s_add_u32 s66, s22, 0
    v_max_f32 v68, 0, v68
    s_waitcnt lgkmcnt(4)
    v_mfma_f32_32x32x16_bf16 v[96:111], a[76:79], v[44:47], v[96:111]
    ds_read_b64_tr_b16 v[40:41], v11 offset:51200
    v_mul_f32 v68, v68, v84
    v_max_f32 v69, 0, v69
    v_mul_f32 v69, v69, v85
    v_cvt_pk_bf16_f32 v50, v68, v69
    v_mfma_f32_32x32x16_bf16 v[112:127], a[188:191], v[44:47], v[112:127]
    ds_read_b64_tr_b16 v[42:43], v11 offset:51456
    buffer_load_dwordx4 v19, s[36:39], s86 offen offset:2048 lds
    v_max_f32 v70, 0, v70
    v_mul_f32 v70, v70, v86
    v_max_f32 v71, 0, v71
    s_waitcnt lgkmcnt(4)
    v_mfma_f32_32x32x16_bf16 v[96:111], a[80:83], v[32:35], v[96:111]
    ds_read_b64_tr_b16 v[44:45], v11 offset:52224
    v_mul_f32 v71, v71, v87
    v_cvt_pk_bf16_f32 v51, v70, v71
    buffer_store_dwordx4 v[48:51], v22, s[16:19], s66 offen offset:0 sc1
    v_max_f32 v72, 0, v72
    v_mfma_f32_32x32x16_bf16 v[112:127], a[192:195], v[32:35], v[112:127]
    ds_read_b64_tr_b16 v[46:47], v11 offset:52480
    v_mul_f32 v72, v72, v88
    v_max_f32 v73, 0, v73
    v_mul_f32 v73, v73, v89
    v_cvt_pk_bf16_f32 v52, v72, v73
    s_waitcnt lgkmcnt(4)
    v_mfma_f32_32x32x16_bf16 v[96:111], a[84:87], v[36:39], v[96:111]
    ds_read_b64_tr_b16 v[32:33], v11 offset:53248
    v_max_f32 v74, 0, v74
    v_cndmask_b32 v10, v128, v132, s[70:71]
    v_cndmask_b32 v17, v129, v133, s[70:71]
    v_cndmask_b32 v18, v130, v134, s[70:71]
    v_cndmask_b32 v30, v131, v135, s[70:71]
    v_mfma_f32_32x32x16_bf16 v[112:127], a[196:199], v[36:39], v[112:127]
    ds_read_b64_tr_b16 v[34:35], v11 offset:53504
    v_mul_f32 v74, v74, v90
    v_max_f32 v75, 0, v75
    buffer_load_dwordx4 v19, s[36:39], s87 offen offset:3072 lds
    v_mul_f32 v75, v75, v91
    s_waitcnt lgkmcnt(4)
    v_mfma_f32_32x32x16_bf16 v[96:111], a[88:91], v[40:43], v[96:111]
    ds_read_b64_tr_b16 v[36:37], v11 offset:54272
    v_cvt_pk_bf16_f32 v53, v74, v75
    v_max_f32 v76, 0, v76
    v_mul_f32 v76, v76, v92
    v_max_f32 v77, 0, v77
    v_mfma_f32_32x32x16_bf16 v[112:127], a[200:203], v[40:43], v[112:127]
    ds_read_b64_tr_b16 v[38:39], v11 offset:54528
    v_mul_f32 v77, v77, v93
    v_cvt_pk_bf16_f32 v54, v76, v77
    v_max_f32 v78, 0, v78
    v_mul_f32 v78, v78, v94
    s_waitcnt lgkmcnt(4)
    v_mfma_f32_32x32x16_bf16 v[96:111], a[92:95], v[44:47], v[96:111]
    ds_read_b64_tr_b16 v[40:41], v11 offset:55296
    v_add_u32 v19, 0x7000, v19
    s_add_u32 m0, s80, 63488
    s_nop 0
    buffer_load_dwordx4 v19, s[36:39], 0 offen offset:0 lds
    v_mfma_f32_32x32x16_bf16 v[112:127], a[204:207], v[44:47], v[112:127]
    ds_read_b64_tr_b16 v[42:43], v11 offset:55552
    v_max_f32 v79, 0, v79
    v_mul_f32 v79, v79, v95
    v_cvt_pk_bf16_f32 v55, v78, v79
    buffer_store_dwordx4 v[52:55], v22, s[16:19], s66 offen offset:512 sc1
    s_waitcnt lgkmcnt(4)
    v_mfma_f32_32x32x16_bf16 v[96:111], a[96:99], v[32:35], v[96:111]
    ds_read_b64_tr_b16 v[44:45], v11 offset:56320
    v_mfma_f32_32x32x16_bf16 v[112:127], a[208:211], v[32:35], v[112:127]
    ds_read_b64_tr_b16 v[46:47], v11 offset:56576
    s_waitcnt vmcnt(13)
    ds_read_b64_tr_b16 v[192:193], v20 offset:4096
    ds_read_b64_tr_b16 v[196:197], v20 offset:4128
    s_waitcnt lgkmcnt(6)
    v_mfma_f32_32x32x16_bf16 v[96:111], a[100:103], v[36:39], v[96:111]
    s_waitcnt lgkmcnt(2)
    s_barrier
    ds_read_b64_tr_b16 v[32:33], v11 offset:0
    buffer_load_dwordx4 v19, s[36:39], s85 offen offset:1024 lds
    v_mfma_f32_32x32x16_bf16 v[112:127], a[212:215], v[36:39], v[112:127]
    ds_read_b64_tr_b16 v[34:35], v11 offset:256
    ds_read_b64_tr_b16 v[200:201], v20 offset:4608
    ds_read_b64_tr_b16 v[204:205], v20 offset:4640
    v_mfma_f32_32x32x16_bf16 v[96:111], a[104:107], v[40:43], v[96:111]
    ds_read_b64_tr_b16 v[36:37], v11 offset:1024
    s_add_u32 m0, s65, 28672
    s_add_u32 s79, s5, 384
    buffer_load_dwordx4 v3, s[16:19], s79 offen sc1 lds
    v_mfma_f32_32x32x16_bf16 v[112:127], a[216:219], v[40:43], v[112:127]
    ds_read_b64_tr_b16 v[38:39], v11 offset:1280
    v_mfma_f32_32x32x16_bf16 v[96:111], a[108:111], v[44:47], v[96:111]
    ds_read_b64_tr_b16 v[40:41], v11 offset:2048
    s_add_u32 m0, s65, 29696
    s_add_u32 s79, s5, 135552
    buffer_load_dwordx4 v3, s[16:19], s79 offen sc1 lds
    v_mfma_f32_32x32x16_bf16 v[112:127], a[220:223], v[44:47], v[112:127]
    ds_read_b64_tr_b16 v[42:43], v11 offset:2304
    s_waitcnt vmcnt(14)
    ds_read_b64_tr_b16 v[194:195], v21 offset:0
    ds_read_b64_tr_b16 v[198:199], v21 offset:32
    s_waitcnt lgkmcnt(8)
    v_mfma_f32_32x32x16_bf16 v[128:143], a[0:3], v[32:35], 0
    ds_read_b64_tr_b16 v[44:45], v11 offset:3072
    s_add_u32 m0, s65, 30720
    s_add_u32 s79, s5, 270720
    buffer_load_dwordx4 v3, s[16:19], s79 offen sc1 lds
    v_mfma_f32_32x32x16_bf16 v[144:159], a[112:115], v[32:35], 0
    ds_read_b64_tr_b16 v[46:47], v11 offset:3328
    ds_read_b64_tr_b16 v[202:203], v21 offset:512
    ds_read_b64_tr_b16 v[206:207], v21 offset:544
    s_waitcnt lgkmcnt(8)
    v_mfma_f32_32x32x16_bf16 v[128:143], a[4:7], v[36:39], v[128:143]
    ds_read_b64_tr_b16 v[32:33], v11 offset:4096
    v_mfma_f32_32x32x8_bf16 v[96:111], v[60:61], v[4:5], v[96:111]
    v_mfma_f32_32x32x8_bf16 v[112:127], v[62:63], v[4:5], v[112:127]
    ds_bpermute_b32 v13, v9, v6 offset:128
    s_add_u32 m0, s65, 31744
    s_add_u32 s79, s5, 405888
    buffer_load_dwordx4 v3, s[16:19], s79 offen sc1 lds
    v_mfma_f32_32x32x16_bf16 v[144:159], a[116:119], v[36:39], v[144:159]
    ds_read_b64_tr_b16 v[34:35], v11 offset:4352
    s_add_u32 m0, s65, 32768
    s_add_u32 s79, s5, 541056
    buffer_load_dwordx4 v3, s[16:19], s79 offen sc1 lds
    s_waitcnt lgkmcnt(9)
    v_mfma_f32_32x32x16_bf16 v[128:143], a[8:11], v[40:43], v[128:143]
    ds_read_b64_tr_b16 v[36:37], v11 offset:5120
    s_waitcnt vmcnt(15)
    ds_read_b64_tr_b16 v[208:209], v21 offset:2048
    ds_read_b64_tr_b16 v[212:213], v21 offset:2080
    s_add_u32 m0, s65, 33792
    s_add_u32 s79, s5, 676224
    buffer_load_dwordx4 v3, s[16:19], s79 offen sc1 lds
    v_mfma_f32_32x32x16_bf16 v[144:159], a[120:123], v[40:43], v[144:159]
    ds_read_b64_tr_b16 v[38:39], v11 offset:5376
    ds_read_b64_tr_b16 v[216:217], v21 offset:2560
    ds_read_b64_tr_b16 v[220:221], v21 offset:2592
    s_waitcnt vmcnt(14)
    ds_read_b64_tr_b16 v[210:211], v21 offset:4096
    ds_read_b64_tr_b16 v[214:215], v21 offset:4128
    s_waitcnt lgkmcnt(13)
    v_mfma_f32_32x32x16_bf16 v[128:143], a[12:15], v[44:47], v[128:143]
    ds_read_b64_tr_b16 v[40:41], v11 offset:6144
    v_max_f32 v96, 0, v96
    s_add_u32 m0, s65, 34816
    s_add_u32 s79, s5, 811392
    buffer_load_dwordx4 v3, s[16:19], s79 offen sc1 lds
    v_mfma_f32_32x32x16_bf16 v[144:159], a[124:127], v[44:47], v[144:159]
    ds_read_b64_tr_b16 v[42:43], v11 offset:6400
    v_mul_f32 v96, v96, v112
    v_max_f32 v97, 0, v97
    ds_read_b64_tr_b16 v[218:219], v21 offset:4608
    ds_read_b64_tr_b16 v[222:223], v21 offset:4640
    s_waitcnt lgkmcnt(12)
    v_mfma_f32_32x32x16_bf16 v[128:143], a[16:19], v[32:35], v[128:143]
    ds_read_b64_tr_b16 v[44:45], v11 offset:7168
    v_mul_f32 v97, v97, v113
    v_cvt_pk_bf16_f32 v48, v96, v97
    v_add_u32 v19, 0x1c00, v19
    s_add_u32 m0, s80, 65536
    s_nop 0
    buffer_load_dwordx4 v19, s[36:39], 0 offen offset:0 lds
    v_mfma_f32_32x32x16_bf16 v[144:159], a[128:131], v[32:35], v[144:159]
    ds_read_b64_tr_b16 v[46:47], v11 offset:7424
    v_max_f32 v98, 0, v98
    v_mul_f32 v98, v98, v114
    s_waitcnt vmcnt(14)
    ds_read_b64_tr_b16 v[224:225], v21 offset:6144
    ds_read_b64_tr_b16 v[228:229], v21 offset:6176
    s_waitcnt lgkmcnt(12)
    v_mfma_f32_32x32x16_bf16 v[128:143], a[20:23], v[36:39], v[128:143]
    ds_read_b64_tr_b16 v[32:33], v11 offset:8192
    v_max_f32 v99, 0, v99
    v_mul_f32 v99, v99, v115
    buffer_load_dwordx4 v19, s[36:39], s85 offen offset:1024 lds
    v_cvt_pk_bf16_f32 v49, v98, v99
    v_mfma_f32_32x32x16_bf16 v[144:159], a[132:135], v[36:39], v[144:159]
    ds_read_b64_tr_b16 v[34:35], v11 offset:8448
    s_add_u32 s66, s22, 8192
    ds_read_b64_tr_b16 v[232:233], v21 offset:6656
    ds_read_b64_tr_b16 v[236:237], v21 offset:6688
    v_max_f32 v100, 0, v100
    s_waitcnt lgkmcnt(10)
    v_mfma_f32_32x32x16_bf16 v[128:143], a[24:27], v[40:43], v[128:143]
    ds_read_b64_tr_b16 v[36:37], v11 offset:9216
    v_mul_f32 v100, v100, v116
    v_add_u32 v19, 0x13400, v19
    s_add_u32 m0, s80, 67584
    s_nop 0
    buffer_load_dwordx4 v19, s[36:39], 0 offen offset:0 lds
    v_mfma_f32_32x32x16_bf16 v[144:159], a[136:139], v[40:43], v[144:159]
    ds_read_b64_tr_b16 v[38:39], v11 offset:9472
    v_max_f32 v101, 0, v101
    v_mul_f32 v101, v101, v117
    v_cvt_pk_bf16_f32 v50, v100, v101
    v_max_f32 v102, 0, v102
    s_waitcnt lgkmcnt(8)
    v_mfma_f32_32x32x16_bf16 v[128:143], a[28:31], v[44:47], v[128:143]
    ds_read_b64_tr_b16 v[40:41], v11 offset:10240
    buffer_load_dwordx4 v19, s[36:39], s85 offen offset:1024 lds
    v_mul_f32 v102, v102, v118
    v_max_f32 v103, 0, v103
    v_mul_f32 v103, v103, v119
    v_mfma_f32_32x32x16_bf16 v[144:159], a[140:143], v[44:47], v[144:159]
    ds_read_b64_tr_b16 v[42:43], v11 offset:10496
    v_cvt_pk_bf16_f32 v51, v102, v103
    buffer_store_dwordx4 v[48:51], v22, s[16:19], s66 offen offset:0 sc1
    v_max_f32 v104, 0, v104
    v_mul_f32 v104, v104, v120
    s_waitcnt lgkmcnt(6)
    v_mfma_f32_32x32x16_bf16 v[128:143], a[32:35], v[32:35], v[128:143]
    ds_read_b64_tr_b16 v[44:45], v11 offset:11264
    s_waitcnt vmcnt(13)
    s_barrier
    s_cmp_lg_u32 s48, 0
    s_cbranch_scc1 noflag_23
    buffer_store_dwordx4 v[12:15], v27, s[16:19], s27 offen offset:0 sc1
noflag_23:
    v_mfma_f32_32x32x16_bf16 v[144:159], a[144:147], v[32:35], v[144:159]
    ds_read_b64_tr_b16 v[46:47], v11 offset:11520
    ds_read_b64_tr_b16 v[226:227], v21 offset:8192
    ds_read_b64_tr_b16 v[230:231], v21 offset:8224
    ds_read_b64_tr_b16 v[234:235], v21 offset:8704
    ds_read_b64_tr_b16 v[238:239], v21 offset:8736
    s_waitcnt lgkmcnt(8)
    v_mfma_f32_32x32x16_bf16 v[128:143], a[36:39], v[36:39], v[128:143]
    ds_read_b64_tr_b16 v[32:33], v11 offset:12288
    v_max_f32 v105, 0, v105
    v_mul_f32 v105, v105, v121
    v_cvt_pk_bf16_f32 v52, v104, v105
    v_max_f32 v106, 0, v106
    v_mfma_f32_32x32x16_bf16 v[144:159], a[148:151], v[36:39], v[144:159]
    ds_read_b64_tr_b16 v[34:35], v11 offset:12544
    v_mul_f32 v106, v106, v122
    v_max_f32 v107, 0, v107
    v_mul_f32 v107, v107, v123
    v_cvt_pk_bf16_f32 v53, v106, v107
    s_waitcnt lgkmcnt(8)
    v_mfma_f32_32x32x16_bf16 v[128:143], a[40:43], v[40:43], v[128:143]
    ds_read_b64_tr_b16 v[36:37], v11 offset:13312
    buffer_load_dwordx4 v19, s[36:39], s86 offen offset:2048 lds
    v_max_f32 v108, 0, v108
    v_mul_f32 v108, v108, v124
    v_max_f32 v109, 0, v109
    v_mfma_f32_32x32x16_bf16 v[144:159], a[152:155], v[40:43], v[144:159]
    ds_read_b64_tr_b16 v[38:39], v11 offset:13568
    v_mul_f32 v109, v109, v125
    v_cvt_pk_bf16_f32 v54, v108, v109
    v_max_f32 v110, 0, v110
    v_mul_f32 v110, v110, v126
    s_waitcnt lgkmcnt(8)
    v_mfma_f32_32x32x16_bf16 v[128:143], a[44:47], v[44:47], v[128:143]
    ds_read_b64_tr_b16 v[40:41], v11 offset:14336
    buffer_load_dwordx4 v19, s[36:39], s87 offen offset:3072 lds
    v_max_f32 v111, 0, v111
    v_mul_f32 v111, v111, v127
    v_cvt_pk_bf16_f32 v55, v110, v111
    v_mfma_f32_32x32x16_bf16 v[144:159], a[156:159], v[44:47], v[144:159]
    ds_read_b64_tr_b16 v[42:43], v11 offset:14592
    buffer_store_dwordx4 v[52:55], v22, s[16:19], s66 offen offset:512 sc1
    s_waitcnt vmcnt(15)
    ds_read_b64_tr_b16 v[240:241], v20 offset:6144
    ds_read_b64_tr_b16 v[244:245], v20 offset:6176
    s_waitcnt lgkmcnt(6)
    v_mfma_f32_32x32x16_bf16 v[128:143], a[48:51], v[32:35], v[128:143]
    ds_read_b64_tr_b16 v[44:45], v11 offset:15360
    ds_read_b64_tr_b16 v[248:249], v20 offset:6656
    ds_read_b64_tr_b16 v[252:253], v20 offset:6688
    v_mfma_f32_32x32x16_bf16 v[144:159], a[160:163], v[32:35], v[144:159]
    ds_read_b64_tr_b16 v[46:47], v11 offset:15616
    s_waitcnt lgkmcnt(8)
    v_mfma_f32_32x32x16_bf16 v[128:143], a[52:55], v[36:39], v[128:143]
    ds_read_b64_tr_b16 v[32:33], v11 offset:16384
    buffer_load_dwordx4 v[4:7], v24, s[16:19], s20 offen offset:1024 sc1
    v_mfma_f32_32x32x16_bf16 v[144:159], a[164:167], v[36:39], v[144:159]
    ds_read_b64_tr_b16 v[34:35], v11 offset:16640
    s_waitcnt lgkmcnt(8)
    v_mfma_f32_32x32x16_bf16 v[128:143], a[56:59], v[40:43], v[128:143]
    ds_read_b64_tr_b16 v[36:37], v11 offset:17408
    v_add_u32 v19, 0x7000, v19
    s_add_u32 m0, s80, 57344
    s_nop 0
    buffer_load_dwordx4 v19, s[36:39], 0 offen offset:0 lds
    v_mfma_f32_32x32x16_bf16 v[144:159], a[168:171], v[40:43], v[144:159]
    ds_read_b64_tr_b16 v[38:39], v11 offset:17664
    s_waitcnt lgkmcnt(4)
    v_mfma_f32_32x32x16_bf16 v[128:143], a[60:63], v[44:47], v[128:143]
    ds_read_b64_tr_b16 v[40:41], v11 offset:18432
    buffer_load_dwordx4 v19, s[36:39], s85 offen offset:1024 lds
    v_mfma_f32_32x32x16_bf16 v[144:159], a[172:175], v[44:47], v[144:159]
    ds_read_b64_tr_b16 v[42:43], v11 offset:18688
    s_waitcnt lgkmcnt(4)
    v_mfma_f32_32x32x16_bf16 v[128:143], a[64:67], v[32:35], v[128:143]
    ds_read_b64_tr_b16 v[44:45], v11 offset:19456
    buffer_load_dwordx4 v19, s[36:39], s86 offen offset:2048 lds
    v_mfma_f32_32x32x16_bf16 v[144:159], a[176:179], v[32:35], v[144:159]
    ds_read_b64_tr_b16 v[46:47], v11 offset:19712
    s_waitcnt lgkmcnt(4)
    v_mfma_f32_32x32x16_bf16 v[128:143], a[68:71], v[36:39], v[128:143]
    ds_read_b64_tr_b16 v[32:33], v11 offset:20480
    buffer_load_dwordx4 v19, s[36:39], s87 offen offset:3072 lds
    ds_read_b64_tr_b16 v[112:113], v29 offset:0
    v_mfma_f32_32x32x16_bf16 v[144:159], a[180:183], v[36:39], v[144:159]
    ds_read_b64_tr_b16 v[34:35], v11 offset:20736
    s_waitcnt lgkmcnt(5)
    v_mfma_f32_32x32x16_bf16 v[128:143], a[72:75], v[40:43], v[128:143]
    ds_read_b64_tr_b16 v[36:37], v11 offset:21504
    v_add_u32 v19, 0x15000, v19
    s_add_u32 m0, s80, 61440
    s_nop 0
    buffer_load_dwordx4 v19, s[36:39], 0 offen offset:0 lds
    v_mfma_f32_32x32x16_bf16 v[144:159], a[184:187], v[40:43], v[144:159]
    ds_read_b64_tr_b16 v[38:39], v11 offset:21760
    s_waitcnt lgkmcnt(5)
    v_mfma_f32_32x32x16_bf16 v[128:143], a[76:79], v[44:47], v[128:143]
    ds_read_b64_tr_b16 v[40:41], v11 offset:22528
    buffer_load_dwordx4 v19, s[36:39], s85 offen offset:1024 lds
    v_mfma_f32_32x32x16_bf16 v[144:159], a[188:191], v[44:47], v[144:159]
    ds_read_b64_tr_b16 v[42:43], v11 offset:22784
    s_waitcnt lgkmcnt(4)
    v_mfma_f32_32x32x16_bf16 v[128:143], a[80:83], v[32:35], v[128:143]
    ds_read_b64_tr_b16 v[44:45], v11 offset:23552
    v_add_u32 v19, 0x1c00, v19
    s_add_u32 m0, s81, 0
    s_nop 0
    buffer_load_dwordx4 v19, s[36:39], 0 offen offset:0 lds
    v_mfma_f32_32x32x16_bf16 v[144:159], a[192:195], v[32:35], v[144:159]
    ds_read_b64_tr_b16 v[46:47], v11 offset:23808
    s_waitcnt lgkmcnt(4)
    v_mfma_f32_32x32x16_bf16 v[128:143], a[84:87], v[36:39], v[128:143]
    ds_read_b64_tr_b16 v[32:33], v11 offset:24576
    buffer_load_dwordx4 v19, s[36:39], s85 offen offset:1024 lds
    s_waitcnt vmcnt(15)
    ds_read_b64_tr_b16 v[242:243], v20 offset:8192
    ds_read_b64_tr_b16 v[246:247], v20 offset:8224
    v_mfma_f32_32x32x16_bf16 v[144:159], a[196:199], v[36:39], v[144:159]
    ds_read_b64_tr_b16 v[34:35], v11 offset:24832
    ds_read_b64_tr_b16 v[250:251], v20 offset:8704
    ds_read_b64_tr_b16 v[254:255], v20 offset:8736
    s_waitcnt lgkmcnt(8)
    v_mfma_f32_32x32x16_bf16 v[128:143], a[88:91], v[40:43], v[128:143]
    ds_read_b64_tr_b16 v[36:37], v11 offset:25600
    v_add_u32 v19, 0x5400, v19
    s_add_u32 m0, s81, 2048
    s_nop 0
    buffer_load_dwordx4 v19, s[36:39], 0 offen offset:0 lds
    v_mfma_f32_32x32x16_bf16 v[144:159], a[200:203], v[40:43], v[144:159]
    ds_read_b64_tr_b16 v[38:39], v11 offset:25856
    s_waitcnt lgkmcnt(8)
    v_mfma_f32_32x32x16_bf16 v[128:143], a[92:95], v[44:47], v[128:143]
    ds_read_b64_tr_b16 v[40:41], v11 offset:26624
    buffer_load_dwordx4 v[124:127], v26, s[16:19], s64 offen offset:0 sc1
    s_waitcnt vmcnt(15)
    ds_read_b64_tr_b16 a[224:225], v20 offset:10240
    ds_read_b64_tr_b16 a[228:229], v20 offset:10272
    v_mfma_f32_32x32x16_bf16 v[144:159], a[204:207], v[44:47], v[144:159]
    ds_read_b64_tr_b16 v[42:43], v11 offset:26880
    ds_read_b64_tr_b16 a[232:233], v20 offset:10752
    ds_read_b64_tr_b16 a[236:237], v20 offset:10784
    s_waitcnt vmcnt(10)
    v_cmp_ne_u64 vcc, s[46:47], v[6:7]
    s_cbranch_vccnz retry_24
back_25:
    v_mov_b32 v6, v5
    v_mov_b32 v5, v4
    s_waitcnt lgkmcnt(10)
    v_mfma_f32_32x32x16_bf16 v[128:143], a[96:99], v[32:35], v[128:143]
    ds_read_b64_tr_b16 v[44:45], v11 offset:27648
    buffer_load_dwordx4 v[100:103], v25, s[16:19], s68 offen sc1
    ds_read_b64_tr_b16 a[226:227], v20 offset:12288
    ds_read_b64_tr_b16 a[230:231], v20 offset:12320
    v_mfma_f32_32x32x8_bf16 v[64:79], v[60:61], v[4:5], 0
    v_mfma_f32_32x32x8_bf16 v[80:95], v[62:63], v[4:5], 0
    ds_bpermute_b32 v121, v9, v6 offset:128
    ds_read_b64_tr_b16 a[234:235], v20 offset:12800
    ds_read_b64_tr_b16 a[238:239], v20 offset:12832
    v_mfma_f32_32x32x16_bf16 v[144:159], a[208:211], v[32:35], v[144:159]
    ds_read_b64_tr_b16 v[46:47], v11 offset:27904
    buffer_load_dwordx4 v19, s[36:39], s85 offen offset:1024 lds
    s_waitcnt lgkmcnt(13)
    v_mfma_f32_32x32x16_bf16 v[128:143], a[100:103], v[36:39], v[128:143]
    s_waitcnt lgkmcnt(0)
    s_barrier
    s_cmp_lg_u32 s48, 0
    s_cbranch_scc1 noflag_26
    buffer_store_dwordx4 v[12:15], v27, s[16:19], s27 offen offset:128 sc1
noflag_26:
    ds_read_b64_tr_b16 v[32:33], v11 offset:28672
    v_mfma_f32_32x32x16_bf16 v[144:159], a[212:215], v[36:39], v[144:159]
    ds_read_b64_tr_b16 v[34:35], v11 offset:28928
    buffer_load_dwordx4 v19, s[36:39], s86 offen offset:2048 lds
    v_mfma_f32_32x32x16_bf16 v[128:143], a[104:107], v[40:43], v[128:143]
    ds_read_b64_tr_b16 v[36:37], v11 offset:29696
    buffer_load_dwordx4 v19, s[36:39], s87 offen offset:3072 lds
    v_mfma_f32_32x32x16_bf16 v[144:159], a[216:219], v[40:43], v[144:159]
    ds_read_b64_tr_b16 v[38:39], v11 offset:29952
    v_mfma_f32_32x32x16_bf16 v[128:143], a[108:111], v[44:47], v[128:143]
    ds_read_b64_tr_b16 v[40:41], v11 offset:30720
    v_add_u32 v19, 0x15000, v19
    s_add_u32 m0, s81, 6144
    s_nop 0
    buffer_load_dwordx4 v19, s[36:39], 0 offen offset:0 lds
    v_mfma_f32_32x32x16_bf16 v[144:159], a[220:223], v[44:47], v[144:159]
    ds_read_b64_tr_b16 v[42:43], v11 offset:30976
    s_waitcnt lgkmcnt(4)
    v_mfma_f32_32x32x16_bf16 v[64:79], a[0:3], v[32:35], v[64:79]
    ds_read_b64_tr_b16 v[44:45], v11 offset:31744
    buffer_load_dwordx4 v19, s[36:39], s85 offen offset:1024 lds
    v_mfma_f32_32x32x16_bf16 v[80:95], a[112:115], v[32:35], v[80:95]
    ds_read_b64_tr_b16 v[46:47], v11 offset:32000
    s_waitcnt lgkmcnt(4)
    v_mfma_f32_32x32x16_bf16 v[64:79], a[4:7], v[36:39], v[64:79]
    ds_read_b64_tr_b16 v[32:33], v11 offset:32768
    v_mfma_f32_32x32x8_bf16 v[128:143], v[56:57], v[4:5], v[128:143]
    v_mfma_f32_32x32x8_bf16 v[144:159], v[58:59], v[4:5], v[144:159]
    ds_bpermute_b32 v120, v9, v6 offset:0
    buffer_load_dwordx4 v19, s[36:39], s86 offen offset:2048 lds
    s_waitcnt vmcnt(15)
    ds_read_b64_tr_b16 a[240:241], v20 offset:0
    ds_read_b64_tr_b16 a[244:245], v20 offset:32
    v_mfma_f32_32x32x16_bf16 v[80:95], a[116:119], v[36:39], v[80:95]
    ds_read_b64_tr_b16 v[34:35], v11 offset:33024
    buffer_load_dwordx4 v19, s[36:39], s87 offen offset:3072 lds
    ds_read_b64_tr_b16 a[248:249], v20 offset:512
    ds_read_b64_tr_b16 a[252:253], v20 offset:544
    s_waitcnt lgkmcnt(9)
    v_mfma_f32_32x32x16_bf16 v[64:79], a[8:11], v[40:43], v[64:79]
    ds_read_b64_tr_b16 v[36:37], v11 offset:33792
    v_mfma_f32_32x32x16_bf16 v[80:95], a[120:123], v[40:43], v[80:95]
    ds_read_b64_tr_b16 v[38:39], v11 offset:34048
    v_add_u32 v19, 0x7000, v19
    s_add_u32 m0, s80, 63488
    s_nop 0
    buffer_load_dwordx4 v19, s[36:39], 0 offen offset:0 lds
    s_waitcnt lgkmcnt(9)
    v_mfma_f32_32x32x16_bf16 v[64:79], a[12:15], v[44:47], v[64:79]
    ds_read_b64_tr_b16 v[40:41], v11 offset:34816
    v_max_f32 v128, 0, v128
    v_mul_f32 v128, v128, v144
    buffer_load_dwordx4 v19, s[36:39], s85 offen offset:1024 lds
    v_max_f32 v129, 0, v129
    v_mfma_f32_32x32x16_bf16 v[80:95], a[124:127], v[44:47], v[80:95]
    ds_read_b64_tr_b16 v[42:43], v11 offset:35072
    v_mul_f32 v129, v129, v145
    s_waitcnt vmcnt(16)
    ds_read_b64_tr_b16 a[242:243], v20 offset:2048
    ds_read_b64_tr_b16 a[246:247], v20 offset:2080
    s_waitcnt lgkmcnt(8)
    v_mfma_f32_32x32x16_bf16 v[64:79], a[16:19], v[32:35], v[64:79]
    ds_read_b64_tr_b16 v[44:45], v11 offset:35840
    v_cvt_pk_bf16_f32 v48, v128, v129
    v_max_f32 v130, 0, v130
    buffer_load_dwordx4 v19, s[36:39], s86 offen offset:2048 lds
    v_mul_f32 v130, v130, v146
    v_mfma_f32_32x32x16_bf16 v[80:95], a[128:131], v[32:35], v[80:95]
    ds_read_b64_tr_b16 v[46:47], v11 offset:36096
    v_max_f32 v131, 0, v131
    ds_read_b64_tr_b16 a[250:251], v20 offset:2560
    ds_read_b64_tr_b16 a[254:255], v20 offset:2592
    v_mul_f32 v131, v131, v147
    s_waitcnt lgkmcnt(8)
    v_mfma_f32_32x32x16_bf16 v[64:79], a[20:23], v[36:39], v[64:79]
    ds_read_b64_tr_b16 v[32:33], v11 offset:36864
    v_cvt_pk_bf16_f32 v49, v130, v131
    buffer_load_dwordx4 v19, s[36:39], s87 offen offset:3072 lds
    s_add_u32 s66, s22, 16384
    v_max_f32 v132, 0, v132
    v_mfma_f32_32x32x16_bf16 v[80:95], a[132:135], v[36:39], v[80:95]
    ds_read_b64_tr_b16 v[34:35], v11 offset:37120
    v_mul_f32 v132, v132, v148
    v_max_f32 v133, 0, v133
    v_mul_f32 v133, v133, v149
    v_cvt_pk_bf16_f32 v50, v132, v133
    s_waitcnt lgkmcnt(8)
    v_mfma_f32_32x32x16_bf16 v[64:79], a[24:27], v[40:43], v[64:79]
    ds_read_b64_tr_b16 v[36:37], v11 offset:37888
    v_max_f32 v134, 0, v134
    v_add_u32 v19, 0x15000, v19
    s_add_u32 m0, s80, 67584
    s_nop 0
    buffer_load_dwordx4 v19, s[36:39], 0 offen offset:0 lds
    v_mfma_f32_32x32x16_bf16 v[80:95], a[136:139], v[40:43], v[80:95]
    ds_read_b64_tr_b16 v[38:39], v11 offset:38144
    v_mul_f32 v134, v134, v150
    v_max_f32 v135, 0, v135
    v_mul_f32 v135, v135, v151
    v_cvt_pk_bf16_f32 v51, v134, v135
    s_waitcnt lgkmcnt(6)
    v_mfma_f32_32x32x16_bf16 v[64:79], a[28:31], v[44:47], v[64:79]
    ds_read_b64_tr_b16 v[40:41], v11 offset:38912
    s_waitcnt vmcnt(13)
    v_cmp_ne_u64 vcc, s[46:47], v[126:127]
    s_cbranch_vccnz retry_27
back_28:
    s_add_u32 s67, s11, 0
    buffer_load_dwordx4 a[0:3], v24, s[16:19], s67 offen offset:0 sc1
    v_mfma_f32_32x32x16_bf16 v[80:95], a[140:143], v[44:47], v[80:95]
    ds_read_b64_tr_b16 v[42:43], v11 offset:39168
    buffer_store_dwordx4 v[48:51], v22, s[16:19], s66 offen offset:0 sc1
    v_max_f32 v136, 0, v136
    v_mul_f32 v136, v136, v152
    v_max_f32 v137, 0, v137
    s_waitcnt lgkmcnt(4)
    v_mfma_f32_32x32x16_bf16 v[64:79], a[32:35], v[32:35], v[64:79]
    ds_read_b64_tr_b16 v[44:45], v11 offset:39936
    v_mul_f32 v137, v137, v153
    v_cvt_pk_bf16_f32 v52, v136, v137
    v_max_f32 v138, 0, v138
    v_mul_f32 v138, v138, v154
    v_mfma_f32_32x32x16_bf16 v[80:95], a[144:147], v[32:35], v[80:95]
    ds_read_b64_tr_b16 v[46:47], v11 offset:40192
    v_max_f32 v139, 0, v139
    v_mul_f32 v139, v139, v155
    v_cvt_pk_bf16_f32 v53, v138, v139
    v_max_f32 v140, 0, v140
    s_waitcnt lgkmcnt(4)
    v_mfma_f32_32x32x16_bf16 v[64:79], a[36:39], v[36:39], v[64:79]
    ds_read_b64_tr_b16 v[32:33], v11 offset:40960
    v_mul_f32 v140, v140, v156
    buffer_load_dwordx4 a[4:7], v24, s[16:19], s67 offen offset:1024 sc1
    v_max_f32 v141, 0, v141
    v_mul_f32 v141, v141, v157
    v_mfma_f32_32x32x16_bf16 v[80:95], a[148:151], v[36:39], v[80:95]
    ds_read_b64_tr_b16 v[34:35], v11 offset:41216
    v_cvt_pk_bf16_f32 v54, v140, v141
    v_max_f32 v142, 0, v142
    v_mul_f32 v142, v142, v158
    v_max_f32 v143, 0, v143
    s_waitcnt lgkmcnt(4)
    v_mfma_f32_32x32x16_bf16 v[64:79], a[40:43], v[40:43], v[64:79]
    ds_read_b64_tr_b16 v[36:37], v11 offset:41984
    v_mul_f32 v143, v143, v159
    s_add_u32 s67, s11, 1064960
    buffer_load_dwordx4 a[8:11], v24, s[16:19], s67 offen offset:0 sc1
    v_cvt_pk_bf16_f32 v55, v142, v143
    v_mfma_f32_32x32x16_bf16 v[80:95], a[152:155], v[40:43], v[80:95]
    ds_read_b64_tr_b16 v[38:39], v11 offset:42240
    buffer_store_dwordx4 v[52:55], v22, s[16:19], s66 offen offset:512 sc1
    ds_read_b64_tr_b16 v[116:117], v29 offset:28672
    s_waitcnt lgkmcnt(5)
    v_mfma_f32_32x32x16_bf16 v[64:79], a[44:47], v[44:47], v[64:79]
    ds_read_b64_tr_b16 v[40:41], v11 offset:43008
    v_mfma_f32_32x32x16_bf16 v[80:95], a[156:159], v[44:47], v[80:95]
    ds_read_b64_tr_b16 v[42:43], v11 offset:43264
    buffer_load_dwordx4 v[124:127], v26, s[16:19], s64 offen offset:128 sc1
    s_waitcnt lgkmcnt(5)
    v_mfma_f32_32x32x16_bf16 v[64:79], a[48:51], v[32:35], v[64:79]
    ds_read_b64_tr_b16 v[44:45], v11 offset:44032
    v_mfma_f32_32x32x16_bf16 v[80:95], a[160:163], v[32:35], v[80:95]
    ds_read_b64_tr_b16 v[46:47], v11 offset:44288
    s_waitcnt lgkmcnt(5)
    v_mfma_f32_32x32x16_bf16 v[64:79], a[52:55], v[36:39], v[64:79]
    ds_read_b64_tr_b16 v[32:33], v11 offset:45056
    v_mfma_f32_32x32x16_bf16 v[80:95], a[164:167], v[36:39], v[80:95]
    ds_read_b64_tr_b16 v[34:35], v11 offset:45312
    buffer_load_dwordx4 a[12:15], v24, s[16:19], s67 offen offset:1024 sc1
    s_waitcnt lgkmcnt(4)
    v_mfma_f32_32x32x16_bf16 v[64:79], a[56:59], v[40:43], v[64:79]
    ds_read_b64_tr_b16 v[36:37], v11 offset:46080
    v_mfma_f32_32x32x16_bf16 v[80:95], a[168:171], v[40:43], v[80:95]
    ds_read_b64_tr_b16 v[38:39], v11 offset:46336
    s_add_u32 s67, s11, 2129920
    buffer_load_dwordx4 a[16:19], v24, s[16:19], s67 offen offset:0 sc1
    s_waitcnt lgkmcnt(4)
    v_mfma_f32_32x32x16_bf16 v[64:79], a[60:63], v[44:47], v[64:79]
    ds_read_b64_tr_b16 v[40:41], v11 offset:47104
    s_waitcnt vmcnt(20)
    v_cmp_ne_u64 vcc, s[46:47], v[102:103]
    s_cbranch_vccnz retry_29
back_30:
    buffer_load_dwordx4 a[20:23], v24, s[16:19], s67 offen offset:1024 sc1
    v_mfma_f32_32x32x16_bf16 v[80:95], a[172:175], v[44:47], v[80:95]
    ds_read_b64_tr_b16 v[42:43], v11 offset:47360
    v_mov_b32 v60, v100
    v_mov_b32 v61, v101
    v_mov_b32 v62, 0x2b800000
    v_permlane32_swap_b32 v100, v60
    s_waitcnt lgkmcnt(4)
    v_mfma_f32_32x32x16_bf16 v[64:79], a[64:67], v[32:35], v[64:79]
    ds_read_b64_tr_b16 v[44:45], v11 offset:48128
    v_permlane32_swap_b32 v101, v61
    buffer_load_dwordx4 v19, s[36:39], s85 offen offset:1024 lds
    v_lshlrev_b32 v96, 16, v100
    v_and_b32 v97, s56, v100
    v_mfma_f32_32x32x16_bf16 v[80:95], a[176:179], v[32:35], v[80:95]
    ds_read_b64_tr_b16 v[46:47], v11 offset:48384
    v_lshlrev_b32 v98, 16, v101
    v_and_b32 v99, s56, v101
    v_lshlrev_b32 v56, 16, v60
    v_and_b32 v57, s56, v60
    s_waitcnt lgkmcnt(4)
    v_mfma_f32_32x32x16_bf16 v[64:79], a[68:71], v[36:39], v[64:79]
    ds_read_b64_tr_b16 v[32:33], v11 offset:49152
    v_lshlrev_b32 v58, 16, v61
    buffer_load_dwordx4 v19, s[36:39], s86 offen offset:2048 lds
    v_and_b32 v59, s56, v61
    v_add_f32 v56, 1.0, v56
    v_mfma_f32_32x32x16_bf16 v[80:95], a[180:183], v[36:39], v[80:95]
    ds_read_b64_tr_b16 v[34:35], v11 offset:49408
    v_add_f32 v57, 1.0, v57
    v_add_f32 v58, 1.0, v58
    v_add_f32 v59, 1.0, v59
    v_cvt_pk_bf16_f32 v60, v56, v57
    s_waitcnt lgkmcnt(4)
    v_mfma_f32_32x32x16_bf16 v[64:79], a[72:75], v[40:43], v[64:79]
    ds_read_b64_tr_b16 v[36:37], v11 offset:50176
    v_cvt_pk_bf16_f32 v61, v58, v59
    buffer_load_dwordx4 v19, s[36:39], s87 offen offset:3072 lds
    v_lshlrev_b32 v56, 16, v60
    v_and_b32 v57, s56, v60
    v_mfma_f32_32x32x16_bf16 v[80:95], a[184:187], v[40:43], v[80:95]
    ds_read_b64_tr_b16 v[38:39], v11 offset:50432
    v_lshlrev_b32 v58, 16, v61
    v_and_b32 v59, s56, v61
    v_cmp_eq_f32 s[70:71], 0, v56
    s_nop 1
    v_cndmask_b32 v56, v56, v62, s[70:71]
    s_waitcnt lgkmcnt(4)
    v_mfma_f32_32x32x16_bf16 v[64:79], a[76:79], v[44:47], v[64:79]
    ds_read_b64_tr_b16 v[40:41], v11 offset:51200
    s_add_u32 s67, s11, 3194880
    buffer_load_dwordx4 a[24:27], v24, s[16:19], s67 offen offset:0 sc1
    v_rcp_f32 v56, v56
    v_mfma_f32_32x32x16_bf16 v[80:95], a[188:191], v[44:47], v[80:95]
    ds_read_b64_tr_b16 v[42:43], v11 offset:51456
    v_cmp_eq_f32 s[70:71], 0, v57
    s_nop 1
    v_cndmask_b32 v57, v57, v62, s[70:71]
    s_waitcnt lgkmcnt(4)
    v_mfma_f32_32x32x16_bf16 v[64:79], a[80:83], v[32:35], v[64:79]
    ds_read_b64_tr_b16 v[44:45], v11 offset:52224
    v_add_u32 v19, 0x7000, v19
    s_add_u32 m0, s80, 57344
    s_nop 0
    buffer_load_dwordx4 v19, s[36:39], 0 offen offset:0 lds
    v_mfma_f32_32x32x16_bf16 v[80:95], a[192:195], v[32:35], v[80:95]
    ds_read_b64_tr_b16 v[46:47], v11 offset:52480
    v_rcp_f32 v57, v57
    v_cmp_eq_f32 s[70:71], 0, v58
    s_nop 1
    v_cndmask_b32 v58, v58, v62, s[70:71]
    s_waitcnt lgkmcnt(4)
    v_mfma_f32_32x32x16_bf16 v[64:79], a[84:87], v[36:39], v[64:79]
    ds_read_b64_tr_b16 v[32:33], v11 offset:53248
    buffer_load_dwordx4 v19, s[36:39], s85 offen offset:1024 lds
    v_rcp_f32 v58, v58
    v_cmp_eq_f32 s[70:71], 0, v59
    v_mfma_f32_32x32x16_bf16 v[80:95], a[196:199], v[36:39], v[80:95]
    ds_read_b64_tr_b16 v[34:35], v11 offset:53504
    v_cndmask_b32 v59, v59, v62, s[70:71]
    v_rcp_f32 v59, v59
    s_waitcnt lgkmcnt(4)
    v_mfma_f32_32x32x16_bf16 v[64:79], a[88:91], v[40:43], v[64:79]
    ds_read_b64_tr_b16 v[36:37], v11 offset:54272
    buffer_load_dwordx4 v19, s[36:39], s86 offen offset:2048 lds
    v_mfma_f32_32x32x16_bf16 v[80:95], a[200:203], v[40:43], v[80:95]
    ds_read_b64_tr_b16 v[38:39], v11 offset:54528
    s_waitcnt lgkmcnt(4)
    v_mfma_f32_32x32x16_bf16 v[64:79], a[92:95], v[44:47], v[64:79]
    ds_read_b64_tr_b16 v[40:41], v11 offset:55296
    s_waitcnt vmcnt(10)
    v_cmp_ne_u64 vcc, s[46:47], v[126:127]
    s_cbranch_vccnz retry_31
back_32:
    s_add_u32 s10, s11, 8192
    buffer_load_dwordx4 a[56:59], v24, s[16:19], s10 offen offset:0 sc1
    v_mfma_f32_32x32x16_bf16 v[80:95], a[204:207], v[44:47], v[80:95]
    ds_read_b64_tr_b16 v[42:43], v11 offset:55552
    s_waitcnt lgkmcnt(4)
    v_mfma_f32_32x32x16_bf16 v[64:79], a[96:99], v[32:35], v[64:79]
    ds_read_b64_tr_b16 v[44:45], v11 offset:56320
    buffer_load_dwordx4 a[60:63], v24, s[16:19], s10 offen offset:1024 sc1
    v_mfma_f32_32x32x16_bf16 v[80:95], a[208:211], v[32:35], v[80:95]
    ds_read_b64_tr_b16 v[46:47], v11 offset:56576
    s_waitcnt lgkmcnt(4)
    v_mfma_f32_32x32x16_bf16 v[64:79], a[100:103], v[36:39], v[64:79]
    s_waitcnt lgkmcnt(0)
    s_barrier
    s_cmp_lg_u32 s48, 0
    s_cbranch_scc1 noflag_33
    buffer_store_dwordx4 v[12:15], v27, s[16:19], s27 offen offset:256 sc1
noflag_33:
    v_mfma_f32_32x32x16_bf16 v[80:95], a[212:215], v[36:39], v[80:95]
    buffer_load_dwordx4 v19, s[36:39], s87 offen offset:3072 lds
    v_mfma_f32_32x32x16_bf16 v[64:79], a[104:107], v[40:43], v[64:79]
    buffer_load_dwordx4 a[28:31], v24, s[16:19], s67 offen offset:1024 sc1
    v_mfma_f32_32x32x16_bf16 v[80:95], a[216:219], v[40:43], v[80:95]
    v_mfma_f32_32x32x16_bf16 v[64:79], a[108:111], v[44:47], v[64:79]
    s_add_u32 s10, s11, 1073152
    buffer_load_dwordx4 a[64:67], v24, s[16:19], s10 offen offset:0 sc1
    v_mfma_f32_32x32x16_bf16 v[80:95], a[220:223], v[44:47], v[80:95]
    v_mfma_f32_16x16x32_bf16 v[128:131], v[160:163], a[0:3], 0
    s_add_u32 s67, s11, 4259840
    buffer_load_dwordx4 a[32:35], v24, s[16:19], s67 offen offset:0 sc1
    v_mfma_f32_16x16x32_bf16 v[132:135], v[164:167], a[0:3], 0
    ds_read_b64_tr_b16 a[112:113], v20 offset:4096
    ds_read_b64_tr_b16 a[116:117], v20 offset:4128
    v_mfma_f32_16x16x32_bf16 v[136:139], v[168:171], a[0:3], 0
    ds_read_b64_tr_b16 a[120:121], v20 offset:4608
    ds_read_b64_tr_b16 a[124:125], v20 offset:4640
    v_mfma_f32_16x16x32_bf16 v[140:143], v[172:175], a[0:3], 0
    ds_read_b64_tr_b16 a[114:115], v21 offset:0
    ds_read_b64_tr_b16 a[118:119], v21 offset:32
    v_mfma_f32_16x16x32_bf16 v[128:131], v[176:179], a[4:7], v[128:131]
    v_max_f32 v64, 0, v64
    v_mul_f32 v64, v64, v80
    v_max_f32 v65, 0, v65
    v_mul_f32 v65, v65, v81
    v_cvt_pk_bf16_f32 v48, v64, v65
    v_max_f32 v66, 0, v66
    v_mfma_f32_16x16x32_bf16 v[132:135], v[180:183], a[4:7], v[132:135]
    v_mul_f32 v66, v66, v82
    v_max_f32 v67, 0, v67
    v_mul_f32 v67, v67, v83
    v_cvt_pk_bf16_f32 v49, v66, v67
    s_add_u32 s66, s22, 24576
    v_max_f32 v68, 0, v68
    v_mfma_f32_16x16x32_bf16 v[136:139], v[184:187], a[4:7], v[136:139]
    v_mul_f32 v68, v68, v84
    v_max_f32 v69, 0, v69
    v_mul_f32 v69, v69, v85
    v_cvt_pk_bf16_f32 v50, v68, v69
    v_max_f32 v70, 0, v70
    v_mul_f32 v70, v70, v86
    v_mfma_f32_16x16x32_bf16 v[140:143], v[188:191], a[4:7], v[140:143]
    v_max_f32 v71, 0, v71
    v_mul_f32 v71, v71, v87
    v_cvt_pk_bf16_f32 v51, v70, v71
    buffer_store_dwordx4 v[48:51], v22, s[16:19], s66 offen offset:0 sc1
    v_max_f32 v72, 0, v72
    v_mul_f32 v72, v72, v88
    v_mfma_f32_16x16x32_bf16 v[128:131], v[192:195], a[8:11], v[128:131]
    v_max_f32 v73, 0, v73
    v_mul_f32 v73, v73, v89
    v_cvt_pk_bf16_f32 v52, v72, v73
    v_max_f32 v74, 0, v74
    v_mul_f32 v74, v74, v90
    v_max_f32 v75, 0, v75
    v_mfma_f32_16x16x32_bf16 v[132:135], v[196:199], a[8:11], v[132:135]
    v_mul_f32 v75, v75, v91
    v_cvt_pk_bf16_f32 v53, v74, v75
    v_max_f32 v76, 0, v76
    v_mul_f32 v76, v76, v92
    v_max_f32 v77, 0, v77
    v_mul_f32 v77, v77, v93
    v_mfma_f32_16x16x32_bf16 v[136:139], v[200:203], a[8:11], v[136:139]
    v_cvt_pk_bf16_f32 v54, v76, v77
    v_max_f32 v78, 0, v78
    v_mul_f32 v78, v78, v94
    v_max_f32 v79, 0, v79
    v_mul_f32 v79, v79, v95
    v_cvt_pk_bf16_f32 v55, v78, v79
    v_mfma_f32_16x16x32_bf16 v[140:143], v[204:207], a[8:11], v[140:143]
    buffer_store_dwordx4 v[52:55], v22, s[16:19], s66 offen offset:512 sc1
    ds_read_b64_tr_b16 a[122:123], v21 offset:512
    ds_read_b64_tr_b16 a[126:127], v21 offset:544
    ds_read_b64_tr_b16 a[128:129], v21 offset:2048
    ds_read_b64_tr_b16 a[132:133], v21 offset:2080
    ds_read_b64_tr_b16 a[136:137], v21 offset:2560
    ds_read_b64_tr_b16 a[140:141], v21 offset:2592
    ds_read_b64_tr_b16 a[130:131], v21 offset:4096
    ds_read_b64_tr_b16 a[134:135], v21 offset:4128
    ds_read_b64_tr_b16 a[138:139], v21 offset:4608
    ds_read_b64_tr_b16 a[142:143], v21 offset:4640
    s_waitcnt vmcnt(17)
    v_mfma_f32_16x16x32_bf16 v[128:131], v[208:211], a[12:15], v[128:131]
    buffer_load_dwordx4 a[68:71], v24, s[16:19], s10 offen offset:1024 sc1
    v_mfma_f32_16x16x32_bf16 v[132:135], v[212:215], a[12:15], v[132:135]
    ds_read_b64_tr_b16 a[144:145], v21 offset:6144
    ds_read_b64_tr_b16 a[148:149], v21 offset:6176
    v_mfma_f32_16x16x32_bf16 v[136:139], v[216:219], a[12:15], v[136:139]
    ds_read_b64_tr_b16 a[152:153], v21 offset:6656
    ds_read_b64_tr_b16 a[156:157], v21 offset:6688
    v_mfma_f32_16x16x32_bf16 v[140:143], v[220:223], a[12:15], v[140:143]
    ds_read_b64_tr_b16 a[146:147], v21 offset:8192
    ds_read_b64_tr_b16 a[150:151], v21 offset:8224
    s_waitcnt vmcnt(17)
    v_mfma_f32_16x16x32_bf16 v[128:131], v[224:227], a[16:19], v[128:131]
    buffer_load_dwordx4 a[36:39], v24, s[16:19], s67 offen offset:1024 sc1
    v_mfma_f32_16x16x32_bf16 v[132:135], v[228:231], a[16:19], v[132:135]
    ds_read_b64_tr_b16 a[154:155], v21 offset:8704
    ds_read_b64_tr_b16 a[158:159], v21 offset:8736
    v_mfma_f32_16x16x32_bf16 v[136:139], v[232:235], a[16:19], v[136:139]
    ds_read_b64_tr_b16 a[160:161], v20 offset:6144
    ds_read_b64_tr_b16 a[164:165], v20 offset:6176
    v_mfma_f32_16x16x32_bf16 v[140:143], v[236:239], a[16:19], v[140:143]
    ds_read_b64_tr_b16 a[168:169], v20 offset:6656
    ds_read_b64_tr_b16 a[172:173], v20 offset:6688
    s_waitcnt vmcnt(17)
    v_mfma_f32_16x16x32_bf16 v[128:131], v[240:243], a[20:23], v[128:131]
    s_add_u32 s10, s11, 2138112
    buffer_load_dwordx4 a[72:75], v24, s[16:19], s10 offen offset:0 sc1
    v_mfma_f32_16x16x32_bf16 v[132:135], v[244:247], a[20:23], v[132:135]
    ds_read_b64_tr_b16 a[162:163], v20 offset:8192
    ds_read_b64_tr_b16 a[166:167], v20 offset:8224
    v_mfma_f32_16x16x32_bf16 v[136:139], v[248:251], a[20:23], v[136:139]
    ds_read_b64_tr_b16 a[170:171], v20 offset:8704
    ds_read_b64_tr_b16 a[174:175], v20 offset:8736
    v_mfma_f32_16x16x32_bf16 v[140:143], v[252:255], a[20:23], v[140:143]
    s_waitcnt vmcnt(17)
    ds_read_b64_tr_b16 a[176:177], v20 offset:10240
    ds_read_b64_tr_b16 a[180:181], v20 offset:10272
    s_waitcnt vmcnt(10)
    v_mfma_f32_16x16x32_bf16 v[144:147], v[160:163], a[56:59], 0
    s_add_u32 s67, s11, 5324800
    buffer_load_dwordx4 a[40:43], v24, s[16:19], s67 offen offset:0 sc1
    v_mfma_f32_16x16x32_bf16 v[148:151], v[164:167], a[56:59], 0
    ds_read_b64_tr_b16 a[184:185], v20 offset:10752
    ds_read_b64_tr_b16 a[188:189], v20 offset:10784
    v_mfma_f32_16x16x32_bf16 v[152:155], v[168:171], a[56:59], 0
    ds_read_b64_tr_b16 a[178:179], v20 offset:12288
    ds_read_b64_tr_b16 a[182:183], v20 offset:12320
    v_mfma_f32_16x16x32_bf16 v[156:159], v[172:175], a[56:59], 0
    ds_read_b64_tr_b16 a[186:187], v20 offset:12800
    ds_read_b64_tr_b16 a[190:191], v20 offset:12832
    v_mfma_f32_16x16x32_bf16 v[128:131], a[224:227], a[24:27], v[128:131]
    buffer_load_dwordx4 a[76:79], v24, s[16:19], s10 offen offset:1024 sc1
    v_mfma_f32_16x16x32_bf16 v[132:135], a[228:231], a[24:27], v[132:135]
    ds_read_b64_tr_b16 a[192:193], v20 offset:0
    ds_read_b64_tr_b16 a[196:197], v20 offset:32
    v_mfma_f32_16x16x32_bf16 v[136:139], a[232:235], a[24:27], v[136:139]
    ds_read_b64_tr_b16 a[200:201], v20 offset:512
    ds_read_b64_tr_b16 a[204:205], v20 offset:544
    v_mfma_f32_16x16x32_bf16 v[140:143], a[236:239], a[24:27], v[140:143]
    s_waitcnt vmcnt(10)
    ds_read_b64_tr_b16 a[194:195], v20 offset:2048
    ds_read_b64_tr_b16 a[198:199], v20 offset:2080
    v_mfma_f32_16x16x32_bf16 v[144:147], v[176:179], a[60:63], v[144:147]
    buffer_load_dwordx4 a[44:47], v24, s[16:19], s67 offen offset:1024 sc1
    v_mfma_f32_16x16x32_bf16 v[148:151], v[180:183], a[60:63], v[148:151]
    ds_read_b64_tr_b16 a[202:203], v20 offset:2560
    ds_read_b64_tr_b16 a[206:207], v20 offset:2592
    v_mfma_f32_16x16x32_bf16 v[152:155], v[184:187], a[60:63], v[152:155]
    ds_bpermute_b32 v32, v16, v10
    ds_bpermute_b32 v33, v16, v17
    v_mfma_f32_16x16x32_bf16 v[156:159], v[188:191], a[60:63], v[156:159]
    ds_bpermute_b32 v34, v16, v18
    ds_bpermute_b32 v35, v16, v30
    s_waitcnt vmcnt(10)
    v_mfma_f32_16x16x32_bf16 v[128:131], a[240:243], a[28:31], v[128:131]
    s_add_u32 s10, s11, 3203072
    buffer_load_dwordx4 a[80:83], v24, s[16:19], s10 offen offset:0 sc1
    v_mfma_f32_16x16x32_bf16 v[132:135], a[244:247], a[28:31], v[132:135]
    ds_bpermute_b32 v36, v16, v112
    ds_bpermute_b32 v37, v16, v113
    v_mfma_f32_16x16x32_bf16 v[136:139], a[248:251], a[28:31], v[136:139]
    ds_bpermute_b32 v38, v16, v116
    ds_bpermute_b32 v39, v16, v117
    v_mfma_f32_16x16x32_bf16 v[140:143], a[252:255], a[28:31], v[140:143]
    buffer_load_dwordx4 v[124:127], v26, s[16:19], s64 offen offset:256 sc1
    s_waitcnt vmcnt(11)
    v_mfma_f32_16x16x32_bf16 v[144:147], v[192:195], a[64:67], v[144:147]
    s_add_u32 s67, s11, 6389760
    buffer_load_dwordx4 a[48:51], v24, s[16:19], s67 offen offset:0 sc1
    v_mfma_f32_16x16x32_bf16 v[148:151], v[196:199], a[64:67], v[148:151]
    v_mfma_f32_16x16x32_bf16 v[152:155], v[200:203], a[64:67], v[152:155]
    s_waitcnt lgkmcnt(0)
    v_lshlrev_b32 v104, 16, v32
    v_mfma_f32_16x16x32_bf16 v[156:159], v[204:207], a[64:67], v[156:159]
    v_mul_f32 v104, v104, v56
    v_and_b32 v105, s56, v32
    s_waitcnt vmcnt(11)
    v_mfma_f32_16x16x32_bf16 v[128:131], a[112:115], a[32:35], v[128:131]
    buffer_load_dwordx4 a[84:87], v24, s[16:19], s10 offen offset:1024 sc1
    v_mfma_f32_16x16x32_bf16 v[132:135], a[116:119], a[32:35], v[132:135]
    v_mul_f32 v105, v105, v57
    v_lshlrev_b32 v106, 16, v33
    v_mfma_f32_16x16x32_bf16 v[136:139], a[120:123], a[32:35], v[136:139]
    v_mul_f32 v106, v106, v58
    v_and_b32 v107, s56, v33
    v_mfma_f32_16x16x32_bf16 v[140:143], a[124:127], a[32:35], v[140:143]
    v_mul_f32 v107, v107, v59
    v_lshlrev_b32 v108, 16, v34
    s_waitcnt vmcnt(9)
    v_mfma_f32_16x16x32_bf16 v[144:147], v[208:211], a[68:71], v[144:147]
    buffer_load_dwordx4 a[52:55], v24, s[16:19], s67 offen offset:1024 sc1
    v_mfma_f32_16x16x32_bf16 v[148:151], v[212:215], a[68:71], v[148:151]
    v_mul_f32 v108, v108, v56
    v_and_b32 v109, s56, v34
    v_mfma_f32_16x16x32_bf16 v[152:155], v[216:219], a[68:71], v[152:155]
    v_mul_f32 v109, v109, v57
    v_lshlrev_b32 v110, 16, v35
    v_mfma_f32_16x16x32_bf16 v[156:159], v[220:223], a[68:71], v[156:159]
    v_mul_f32 v110, v110, v58
    v_and_b32 v111, s56, v35
    s_waitcnt vmcnt(9)
    v_mfma_f32_16x16x32_bf16 v[128:131], a[128:131], a[36:39], v[128:131]
    s_add_u32 s10, s11, 4268032
    buffer_load_dwordx4 a[88:91], v24, s[16:19], s10 offen offset:0 sc1
    v_mfma_f32_16x16x32_bf16 v[132:135], a[132:135], a[36:39], v[132:135]
    v_mul_f32 v111, v111, v59
    v_lshlrev_b32 v112, 16, v36
    v_mfma_f32_16x16x32_bf16 v[136:139], a[136:139], a[36:39], v[136:139]
    v_mul_f32 v112, v112, v56
    v_and_b32 v113, s56, v36
    v_mfma_f32_16x16x32_bf16 v[140:143], a[140:143], a[36:39], v[140:143]
    v_mul_f32 v113, v113, v57
    v_lshlrev_b32 v114, 16, v37
    s_barrier
    s_cmp_lg_u32 s48, 0
    s_cbranch_scc1 noflag_34
    buffer_store_dwordx4 v[12:15], v27, s[16:19], s27 offen offset:384 sc1
noflag_34:
    s_waitcnt vmcnt(4)
    v_cmp_ne_u64 vcc, s[46:47], v[126:127]
    s_cbranch_vccnz retry_35
back_36:
    v_mfma_f32_16x16x32_bf16 v[144:147], v[224:227], a[72:75], v[144:147]
    buffer_load_dwordx4 a[92:95], v24, s[16:19], s10 offen offset:1024 sc1
    v_mfma_f32_16x16x32_bf16 v[148:151], v[228:231], a[72:75], v[148:151]
    v_mul_f32 v114, v114, v58
    v_and_b32 v115, s56, v37
    v_mfma_f32_16x16x32_bf16 v[152:155], v[232:235], a[72:75], v[152:155]
    v_mul_f32 v115, v115, v59
    v_lshlrev_b32 v116, 16, v38
    v_mfma_f32_16x16x32_bf16 v[156:159], v[236:239], a[72:75], v[156:159]
    v_mul_f32 v116, v116, v56
    v_and_b32 v117, s56, v38
    v_mfma_f32_16x16x32_bf16 v[128:131], a[144:147], a[40:43], v[128:131]
    s_add_u32 s10, s11, 5332992
    buffer_load_dwordx4 a[96:99], v24, s[16:19], s10 offen offset:0 sc1
    v_mfma_f32_16x16x32_bf16 v[132:135], a[148:151], a[40:43], v[132:135]
    v_mul_f32 v117, v117, v57
    v_lshlrev_b32 v118, 16, v39
    v_mfma_f32_16x16x32_bf16 v[136:139], a[152:155], a[40:43], v[136:139]
    v_mul_f32 v118, v118, v58
    v_and_b32 v119, s56, v39
    v_mfma_f32_16x16x32_bf16 v[140:143], a[156:159], a[40:43], v[140:143]
    v_mul_f32 v119, v119, v59
    v_mfma_f32_16x16x32_bf16 v[144:147], v[240:243], a[76:79], v[144:147]
    buffer_load_dwordx4 a[100:103], v24, s[16:19], s10 offen offset:1024 sc1
    v_mfma_f32_16x16x32_bf16 v[148:151], v[244:247], a[76:79], v[148:151]
    v_mfma_f32_16x16x32_bf16 v[152:155], v[248:251], a[76:79], v[152:155]
    v_mfma_f32_16x16x32_bf16 v[156:159], v[252:255], a[76:79], v[156:159]
    v_mfma_f32_16x16x32_bf16 v[128:131], a[160:163], a[44:47], v[128:131]
    s_add_u32 s10, s11, 6397952
    buffer_load_dwordx4 a[104:107], v24, s[16:19], s10 offen offset:0 sc1
    v_mfma_f32_16x16x32_bf16 v[132:135], a[164:167], a[44:47], v[132:135]
    v_mfma_f32_16x16x32_bf16 v[136:139], a[168:171], a[44:47], v[136:139]
    v_mfma_f32_16x16x32_bf16 v[140:143], a[172:175], a[44:47], v[140:143]
    v_mfma_f32_16x16x32_bf16 v[144:147], a[224:227], a[80:83], v[144:147]
    buffer_load_dwordx4 a[108:111], v24, s[16:19], s10 offen offset:1024 sc1
    v_mfma_f32_16x16x32_bf16 v[148:151], a[228:231], a[80:83], v[148:151]
    v_mfma_f32_16x16x32_bf16 v[152:155], a[232:235], a[80:83], v[152:155]
    v_mfma_f32_16x16x32_bf16 v[156:159], a[236:239], a[80:83], v[156:159]
    s_waitcnt vmcnt(8)
    v_mfma_f32_16x16x32_bf16 v[128:131], a[176:179], a[48:51], v[128:131]
    s_add_u32 s9, s11, 16384
    buffer_load_dwordx4 a[0:3], v24, s[16:19], s9 offen offset:0 sc1
    v_mfma_f32_16x16x32_bf16 v[132:135], a[180:183], a[48:51], v[132:135]
    v_mfma_f32_16x16x32_bf16 v[136:139], a[184:187], a[48:51], v[136:139]
    v_mfma_f32_16x16x32_bf16 v[140:143], a[188:191], a[48:51], v[140:143]
    s_waitcnt vmcnt(8)
    v_mfma_f32_16x16x32_bf16 v[144:147], a[240:243], a[84:87], v[144:147]
    buffer_load_dwordx4 a[4:7], v24, s[16:19], s9 offen offset:1024 sc1
    v_mfma_f32_16x16x32_bf16 v[148:151], a[244:247], a[84:87], v[148:151]
    v_mfma_f32_16x16x32_bf16 v[152:155], a[248:251], a[84:87], v[152:155]
    v_mfma_f32_16x16x32_bf16 v[156:159], a[252:255], a[84:87], v[156:159]
    s_waitcnt vmcnt(8)
    v_mfma_f32_16x16x32_bf16 v[128:131], a[192:195], a[52:55], v[128:131]
    s_add_u32 s9, s11, 1081344
    buffer_load_dwordx4 a[8:11], v24, s[16:19], s9 offen offset:0 sc1
    v_mfma_f32_16x16x32_bf16 v[132:135], a[196:199], a[52:55], v[132:135]
    v_mfma_f32_16x16x32_bf16 v[136:139], a[200:203], a[52:55], v[136:139]
    v_mfma_f32_16x16x32_bf16 v[140:143], a[204:207], a[52:55], v[140:143]
    s_waitcnt vmcnt(8)
    v_mfma_f32_16x16x32_bf16 v[144:147], a[112:115], a[88:91], v[144:147]
    buffer_load_dwordx4 a[12:15], v24, s[16:19], s9 offen offset:1024 sc1
    v_mfma_f32_16x16x32_bf16 v[148:151], a[116:119], a[88:91], v[148:151]
    v_mul_f32 v100, v96, v12
    v_mul_f32 v101, v97, v12
    v_mfma_f32_16x16x32_bf16 v[152:155], a[120:123], a[88:91], v[152:155]
    v_mul_f32 v102, v98, v12
    v_mul_f32 v103, v99, v12
    v_mfma_f32_16x16x32_bf16 v[156:159], a[124:127], a[88:91], v[156:159]
    s_add_u32 s60, s24, 0
    ds_write_b128 v8, v[128:131] offset:0
    s_add_u32 s9, s11, 2146304
    buffer_load_dwordx4 a[16:19], v24, s[16:19], s9 offen offset:0 sc1
    s_waitcnt vmcnt(9)
    v_mfma_f32_16x16x32_bf16 v[144:147], a[128:131], a[92:95], v[144:147]
    buffer_load_dwordx4 a[20:23], v24, s[16:19], s9 offen offset:1024 sc1
    v_mfma_f32_16x16x32_bf16 v[148:151], a[132:135], a[92:95], v[148:151]
    v_mfma_f32_16x16x32_bf16 v[152:155], a[136:139], a[92:95], v[152:155]
    v_mfma_f32_16x16x32_bf16 v[156:159], a[140:143], a[92:95], v[156:159]
    s_waitcnt vmcnt(9)
    v_mfma_f32_16x16x32_bf16 v[144:147], a[144:147], a[96:99], v[144:147]
    s_add_u32 s9, s11, 3211264
    buffer_load_dwordx4 a[24:27], v24, s[16:19], s9 offen offset:0 sc1
    v_mfma_f32_16x16x32_bf16 v[148:151], a[148:151], a[96:99], v[148:151]
    ds_write_b128 v8, v[132:135] offset:64
    v_mfma_f32_16x16x32_bf16 v[152:155], a[152:155], a[96:99], v[152:155]
    v_mfma_f32_16x16x32_bf16 v[156:159], a[156:159], a[96:99], v[156:159]
    s_waitcnt vmcnt(9)
    v_mfma_f32_16x16x32_bf16 v[144:147], a[160:163], a[100:103], v[144:147]
    buffer_load_dwordx4 a[28:31], v24, s[16:19], s9 offen offset:1024 sc1
    v_mfma_f32_16x16x32_bf16 v[148:151], a[164:167], a[100:103], v[148:151]
    ds_write_b128 v8, v[136:139] offset:128
    v_mfma_f32_16x16x32_bf16 v[152:155], a[168:171], a[100:103], v[152:155]
    v_mfma_f32_16x16x32_bf16 v[156:159], a[172:175], a[100:103], v[156:159]
    buffer_load_dwordx4 v[124:127], v26, s[16:19], s64 offen offset:384 sc1
    s_waitcnt vmcnt(10)
    v_mfma_f32_16x16x32_bf16 v[144:147], a[176:179], a[104:107], v[144:147]
    s_add_u32 s9, s11, 4276224
    buffer_load_dwordx4 a[32:35], v24, s[16:19], s9 offen offset:0 sc1
    v_mfma_f32_16x16x32_bf16 v[148:151], a[180:183], a[104:107], v[148:151]
    v_mfma_f32_16x16x32_bf16 v[152:155], a[184:187], a[104:107], v[152:155]
    ds_write_b128 v8, v[140:143] offset:192
    v_mfma_f32_16x16x32_bf16 v[156:159], a[188:191], a[104:107], v[156:159]
    s_waitcnt vmcnt(10)
    v_mfma_f32_16x16x32_bf16 v[144:147], a[192:195], a[108:111], v[144:147]
    buffer_load_dwordx4 a[36:39], v24, s[16:19], s9 offen offset:1024 sc1
    v_mfma_f32_16x16x32_bf16 v[148:151], a[196:199], a[108:111], v[148:151]
    v_mfma_f32_16x16x32_bf16 v[152:155], a[200:203], a[108:111], v[152:155]
    s_waitcnt lgkmcnt(0)
    s_barrier
    v_mfma_f32_16x16x32_bf16 v[156:159], a[204:207], a[108:111], v[156:159]
    ds_read_b128 v[32:35], v28 offset:0
    ds_read_b128 v[36:39], v28 offset:4352
    s_waitcnt vmcnt(10)
    v_mfma_f32_16x16x32_bf16 v[64:67], v[160:163], a[0:3], 0
    s_add_u32 s9, s11, 5341184
    buffer_load_dwordx4 a[40:43], v24, s[16:19], s9 offen offset:0 sc1
    v_mfma_f32_16x16x32_bf16 v[68:71], v[164:167], a[0:3], 0
    ds_read_b128 v[40:43], v28 offset:8704
    ds_read_b128 v[44:47], v28 offset:13056
    v_mfma_f32_16x16x32_bf16 v[72:75], v[168:171], a[0:3], 0
    v_mfma_f32_16x16x32_bf16 v[76:79], v[172:175], a[0:3], 0
    s_waitcnt lgkmcnt(2)
    v_add_f32 v32, v32, v36
    s_waitcnt vmcnt(10)
    v_mfma_f32_16x16x32_bf16 v[64:67], v[176:179], a[4:7], v[64:67]
    buffer_load_dwordx4 a[44:47], v24, s[16:19], s9 offen offset:1024 sc1
    v_mfma_f32_16x16x32_bf16 v[68:71], v[180:183], a[4:7], v[68:71]
    v_add_f32 v33, v33, v37
    v_add_f32 v34, v34, v38
    v_mfma_f32_16x16x32_bf16 v[72:75], v[184:187], a[4:7], v[72:75]
    v_add_f32 v35, v35, v39
    s_waitcnt lgkmcnt(0)
    v_mfma_f32_16x16x32_bf16 v[76:79], v[188:191], a[4:7], v[76:79]
    v_add_f32 v40, v40, v44
    v_add_f32 v41, v41, v45
    s_waitcnt vmcnt(10)
    v_mfma_f32_16x16x32_bf16 v[64:67], v[192:195], a[8:11], v[64:67]
    s_add_u32 s9, s11, 6406144
    buffer_load_dwordx4 a[48:51], v24, s[16:19], s9 offen offset:0 sc1
    v_mfma_f32_16x16x32_bf16 v[68:71], v[196:199], a[8:11], v[68:71]
    v_add_f32 v42, v42, v46
    v_add_f32 v43, v43, v47
    v_mfma_f32_16x16x32_bf16 v[72:75], v[200:203], a[8:11], v[72:75]
    v_add_f32 v32, v32, v40
    v_add_f32 v33, v33, v41
    v_mfma_f32_16x16x32_bf16 v[76:79], v[204:207], a[8:11], v[76:79]
    v_add_f32 v34, v34, v42
    v_add_f32 v35, v35, v43
    s_waitcnt vmcnt(10)
    v_mfma_f32_16x16x32_bf16 v[64:67], v[208:211], a[12:15], v[64:67]
    buffer_load_dwordx4 a[52:55], v24, s[16:19], s9 offen offset:1024 sc1
    v_mfma_f32_16x16x32_bf16 v[68:71], v[212:215], a[12:15], v[68:71]
    v_fma_f32 v32, v32, v100, v104
    v_fma_f32 v33, v33, v101, v105
    v_mfma_f32_16x16x32_bf16 v[72:75], v[216:219], a[12:15], v[72:75]
    v_fma_f32 v34, v34, v102, v106
    v_fma_f32 v35, v35, v103, v107
    v_mfma_f32_16x16x32_bf16 v[76:79], v[220:223], a[12:15], v[76:79]
    v_cvt_pk_bf16_f32 v104, v32, v33
    v_cvt_pk_bf16_f32 v105, v34, v35
    s_waitcnt vmcnt(10)
    v_mfma_f32_16x16x32_bf16 v[64:67], v[224:227], a[16:19], v[64:67]
    buffer_store_dwordx2 v[104:105], v31, s[40:43], s60 offen sc1
    v_mul_f32 v100, v96, v13
    v_mfma_f32_16x16x32_bf16 v[68:71], v[228:231], a[16:19], v[68:71]
    v_mul_f32 v101, v97, v13
    v_mul_f32 v102, v98, v13
    v_mfma_f32_16x16x32_bf16 v[72:75], v[232:235], a[16:19], v[72:75]
    v_mul_f32 v103, v99, v13
    s_add_u32 s61, s24, 458752
    v_mfma_f32_16x16x32_bf16 v[76:79], v[236:239], a[16:19], v[76:79]
    ds_write_b128 v8, v[144:147] offset:17408
    s_waitcnt vmcnt(10)
    v_mfma_f32_16x16x32_bf16 v[64:67], v[240:243], a[20:23], v[64:67]
    v_mfma_f32_16x16x32_bf16 v[68:71], v[244:247], a[20:23], v[68:71]
    v_mfma_f32_16x16x32_bf16 v[72:75], v[248:251], a[20:23], v[72:75]
    ds_write_b128 v8, v[148:151] offset:17472
    v_mfma_f32_16x16x32_bf16 v[76:79], v[252:255], a[20:23], v[76:79]
    s_waitcnt vmcnt(9)
    v_mfma_f32_16x16x32_bf16 v[64:67], a[224:227], a[24:27], v[64:67]
    v_mfma_f32_16x16x32_bf16 v[68:71], a[228:231], a[24:27], v[68:71]
    v_mfma_f32_16x16x32_bf16 v[72:75], a[232:235], a[24:27], v[72:75]
    ds_write_b128 v8, v[152:155] offset:17536
    v_mfma_f32_16x16x32_bf16 v[76:79], a[236:239], a[24:27], v[76:79]
    s_waitcnt vmcnt(8)
    v_mfma_f32_16x16x32_bf16 v[64:67], a[240:243], a[28:31], v[64:67]
    v_mfma_f32_16x16x32_bf16 v[68:71], a[244:247], a[28:31], v[68:71]
    ds_write_b128 v8, v[156:159] offset:17600
    v_mfma_f32_16x16x32_bf16 v[72:75], a[248:251], a[28:31], v[72:75]
    v_mfma_f32_16x16x32_bf16 v[76:79], a[252:255], a[28:31], v[76:79]
    s_waitcnt vmcnt(7)
    v_cmp_ne_u64 vcc, s[46:47], v[126:127]
    s_cbranch_vccnz retry_37
back_38:
    s_add_u32 s8, s11, 24576
    buffer_load_dwordx4 a[56:59], v24, s[16:19], s8 offen offset:0 sc1
    buffer_load_dwordx4 a[60:63], v24, s[16:19], s8 offen offset:1024 sc1
    s_add_u32 s8, s11, 1089536
    buffer_load_dwordx4 a[64:67], v24, s[16:19], s8 offen offset:0 sc1
    buffer_load_dwordx4 a[68:71], v24, s[16:19], s8 offen offset:1024 sc1
    s_waitcnt vmcnt(10)
    v_mfma_f32_16x16x32_bf16 v[64:67], a[112:115], a[32:35], v[64:67]
    s_add_u32 s8, s11, 2154496
    buffer_load_dwordx4 a[72:75], v24, s[16:19], s8 offen offset:0 sc1
    v_mfma_f32_16x16x32_bf16 v[68:71], a[116:119], a[32:35], v[68:71]
    v_mfma_f32_16x16x32_bf16 v[72:75], a[120:123], a[32:35], v[72:75]
    s_waitcnt lgkmcnt(0)
    s_barrier
    v_mfma_f32_16x16x32_bf16 v[76:79], a[124:127], a[32:35], v[76:79]
    ds_read_b128 v[48:51], v28 offset:17408
    ds_read_b128 v[52:55], v28 offset:21760
    s_waitcnt vmcnt(10)
    v_mfma_f32_16x16x32_bf16 v[64:67], a[128:131], a[36:39], v[64:67]
    buffer_load_dwordx4 a[76:79], v24, s[16:19], s8 offen offset:1024 sc1
    v_mfma_f32_16x16x32_bf16 v[68:71], a[132:135], a[36:39], v[68:71]
    ds_read_b128 v[56:59], v28 offset:26112
    ds_read_b128 v[60:63], v28 offset:30464
    v_mfma_f32_16x16x32_bf16 v[72:75], a[136:139], a[36:39], v[72:75]
    v_mfma_f32_16x16x32_bf16 v[76:79], a[140:143], a[36:39], v[76:79]
    s_waitcnt lgkmcnt(2)
    v_add_f32 v48, v48, v52
    s_waitcnt vmcnt(10)
    v_mfma_f32_16x16x32_bf16 v[64:67], a[144:147], a[40:43], v[64:67]
    s_add_u32 s8, s11, 3219456
    buffer_load_dwordx4 a[80:83], v24, s[16:19], s8 offen offset:0 sc1
    v_mfma_f32_16x16x32_bf16 v[68:71], a[148:151], a[40:43], v[68:71]
    v_add_f32 v49, v49, v53
    v_add_f32 v50, v50, v54
    v_mfma_f32_16x16x32_bf16 v[72:75], a[152:155], a[40:43], v[72:75]
    v_add_f32 v51, v51, v55
    s_waitcnt lgkmcnt(0)
    v_mfma_f32_16x16x32_bf16 v[76:79], a[156:159], a[40:43], v[76:79]
    v_add_f32 v56, v56, v60
    v_add_f32 v57, v57, v61
    s_waitcnt vmcnt(10)
    v_mfma_f32_16x16x32_bf16 v[64:67], a[160:163], a[44:47], v[64:67]
    buffer_load_dwordx4 a[84:87], v24, s[16:19], s8 offen offset:1024 sc1
    v_mfma_f32_16x16x32_bf16 v[68:71], a[164:167], a[44:47], v[68:71]
    v_add_f32 v58, v58, v62
    v_add_f32 v59, v59, v63
    v_mfma_f32_16x16x32_bf16 v[72:75], a[168:171], a[44:47], v[72:75]
    v_add_f32 v48, v48, v56
    v_add_f32 v49, v49, v57
    v_mfma_f32_16x16x32_bf16 v[76:79], a[172:175], a[44:47], v[76:79]
    v_add_f32 v50, v50, v58
    v_add_f32 v51, v51, v59
    s_waitcnt vmcnt(10)
    v_mfma_f32_16x16x32_bf16 v[64:67], a[176:179], a[48:51], v[64:67]
    s_add_u32 s8, s11, 4284416
    buffer_load_dwordx4 a[88:91], v24, s[16:19], s8 offen offset:0 sc1
    v_mfma_f32_16x16x32_bf16 v[68:71], a[180:183], a[48:51], v[68:71]
    v_fma_f32 v48, v48, v100, v108
    v_fma_f32 v49, v49, v101, v109
    v_mfma_f32_16x16x32_bf16 v[72:75], a[184:187], a[48:51], v[72:75]
    v_fma_f32 v50, v50, v102, v110
    v_fma_f32 v51, v51, v103, v111
    v_mfma_f32_16x16x32_bf16 v[76:79], a[188:191], a[48:51], v[76:79]
    v_cvt_pk_bf16_f32 v108, v48, v49
    v_cvt_pk_bf16_f32 v109, v50, v51
    s_waitcnt vmcnt(10)
    v_mfma_f32_16x16x32_bf16 v[64:67], a[192:195], a[52:55], v[64:67]
    buffer_load_dwordx4 a[92:95], v24, s[16:19], s8 offen offset:1024 sc1
    v_mfma_f32_16x16x32_bf16 v[68:71], a[196:199], a[52:55], v[68:71]
    buffer_store_dwordx2 v[108:109], v31, s[40:43], s61 offen sc1
    v_mfma_f32_16x16x32_bf16 v[72:75], a[200:203], a[52:55], v[72:75]
    v_mfma_f32_16x16x32_bf16 v[76:79], a[204:207], a[52:55], v[76:79]
    s_waitcnt vmcnt(10)
    v_mfma_f32_16x16x32_bf16 v[80:83], v[160:163], a[56:59], 0
    s_add_u32 s8, s11, 5349376
    buffer_load_dwordx4 a[96:99], v24, s[16:19], s8 offen offset:0 sc1
    v_mfma_f32_16x16x32_bf16 v[84:87], v[164:167], a[56:59], 0
    v_mul_f32 v100, v96, v120
    v_mul_f32 v101, v97, v120
    v_mfma_f32_16x16x32_bf16 v[88:91], v[168:171], a[56:59], 0
    v_mul_f32 v102, v98, v120
    v_mul_f32 v103, v99, v120
    v_mfma_f32_16x16x32_bf16 v[92:95], v[172:175], a[56:59], 0
    s_add_u32 s60, s24, 917504
    ds_write_b128 v8, v[64:67] offset:34816
    s_waitcnt vmcnt(10)
    v_mfma_f32_16x16x32_bf16 v[80:83], v[176:179], a[60:63], v[80:83]
    buffer_load_dwordx4 a[100:103], v24, s[16:19], s8 offen offset:1024 sc1
    v_mfma_f32_16x16x32_bf16 v[84:87], v[180:183], a[60:63], v[84:87]
    v_mfma_f32_16x16x32_bf16 v[88:91], v[184:187], a[60:63], v[88:91]
    v_mfma_f32_16x16x32_bf16 v[92:95], v[188:191], a[60:63], v[92:95]
    s_waitcnt vmcnt(10)
    v_mfma_f32_16x16x32_bf16 v[80:83], v[192:195], a[64:67], v[80:83]
    s_add_u32 s8, s11, 6414336
    buffer_load_dwordx4 a[104:107], v24, s[16:19], s8 offen offset:0 sc1
    v_mfma_f32_16x16x32_bf16 v[84:87], v[196:199], a[64:67], v[84:87]
    ds_write_b128 v8, v[68:71] offset:34880
    v_mfma_f32_16x16x32_bf16 v[88:91], v[200:203], a[64:67], v[88:91]
    v_mfma_f32_16x16x32_bf16 v[92:95], v[204:207], a[64:67], v[92:95]
    s_waitcnt vmcnt(10)
    v_mfma_f32_16x16x32_bf16 v[80:83], v[208:211], a[68:71], v[80:83]
    buffer_load_dwordx4 a[108:111], v24, s[16:19], s8 offen offset:1024 sc1
    v_mfma_f32_16x16x32_bf16 v[84:87], v[212:215], a[68:71], v[84:87]
    ds_write_b128 v8, v[72:75] offset:34944
    v_mfma_f32_16x16x32_bf16 v[88:91], v[216:219], a[68:71], v[88:91]
    v_mfma_f32_16x16x32_bf16 v[92:95], v[220:223], a[68:71], v[92:95]
    s_waitcnt vmcnt(10)
    v_mfma_f32_16x16x32_bf16 v[80:83], v[224:227], a[72:75], v[80:83]
    v_mfma_f32_16x16x32_bf16 v[84:87], v[228:231], a[72:75], v[84:87]
    ds_write_b128 v8, v[76:79] offset:35008
    v_mfma_f32_16x16x32_bf16 v[88:91], v[232:235], a[72:75], v[88:91]
    v_mfma_f32_16x16x32_bf16 v[92:95], v[236:239], a[72:75], v[92:95]
    s_waitcnt vmcnt(9)
    v_mfma_f32_16x16x32_bf16 v[80:83], v[240:243], a[76:79], v[80:83]
    s_waitcnt lgkmcnt(0)
    s_barrier
    v_mfma_f32_16x16x32_bf16 v[84:87], v[244:247], a[76:79], v[84:87]
    ds_read_b128 v[32:35], v28 offset:34816
    ds_read_b128 v[36:39], v28 offset:39168
    v_mfma_f32_16x16x32_bf16 v[88:91], v[248:251], a[76:79], v[88:91]
    ds_read_b128 v[40:43], v28 offset:43520
    ds_read_b128 v[44:47], v28 offset:47872
    v_mfma_f32_16x16x32_bf16 v[92:95], v[252:255], a[76:79], v[92:95]
    s_waitcnt vmcnt(8)
    v_mfma_f32_16x16x32_bf16 v[80:83], a[224:227], a[80:83], v[80:83]
    s_waitcnt lgkmcnt(2)
    v_add_f32 v32, v32, v36
    v_mfma_f32_16x16x32_bf16 v[84:87], a[228:231], a[80:83], v[84:87]
    v_add_f32 v33, v33, v37
    v_add_f32 v34, v34, v38
    v_mfma_f32_16x16x32_bf16 v[88:91], a[232:235], a[80:83], v[88:91]
    v_add_f32 v35, v35, v39
    s_waitcnt lgkmcnt(0)
    v_mfma_f32_16x16x32_bf16 v[92:95], a[236:239], a[80:83], v[92:95]
    v_add_f32 v40, v40, v44
    v_add_f32 v41, v41, v45
    s_waitcnt vmcnt(7)
    v_mfma_f32_16x16x32_bf16 v[80:83], a[240:243], a[84:87], v[80:83]
    v_add_f32 v42, v42, v46
    v_add_f32 v43, v43, v47
    v_mfma_f32_16x16x32_bf16 v[84:87], a[244:247], a[84:87], v[84:87]
    v_add_f32 v32, v32, v40
    v_add_f32 v33, v33, v41
    v_mfma_f32_16x16x32_bf16 v[88:91], a[248:251], a[84:87], v[88:91]
    v_add_f32 v34, v34, v42
    v_add_f32 v35, v35, v43
    v_mfma_f32_16x16x32_bf16 v[92:95], a[252:255], a[84:87], v[92:95]
    v_fma_f32 v32, v32, v100, v112
    v_fma_f32 v33, v33, v101, v113
    s_waitcnt vmcnt(6)
    v_mfma_f32_16x16x32_bf16 v[80:83], a[112:115], a[88:91], v[80:83]
    v_fma_f32 v34, v34, v102, v114
    v_fma_f32 v35, v35, v103, v115
    v_mfma_f32_16x16x32_bf16 v[84:87], a[116:119], a[88:91], v[84:87]
    v_cvt_pk_bf16_f32 v112, v32, v33
    v_cvt_pk_bf16_f32 v113, v34, v35
    v_mfma_f32_16x16x32_bf16 v[88:91], a[120:123], a[88:91], v[88:91]
    buffer_store_dwordx2 v[112:113], v31, s[40:43], s60 offen sc1
    v_mul_f32 v100, v96, v121
    v_mfma_f32_16x16x32_bf16 v[92:95], a[124:127], a[88:91], v[92:95]
    v_mul_f32 v101, v97, v121
    v_mul_f32 v102, v98, v121
    s_waitcnt vmcnt(6)
    v_mfma_f32_16x16x32_bf16 v[80:83], a[128:131], a[92:95], v[80:83]
    v_mul_f32 v103, v99, v121
    s_add_u32 s61, s24, 1376256
    v_mfma_f32_16x16x32_bf16 v[84:87], a[132:135], a[92:95], v[84:87]
    v_mfma_f32_16x16x32_bf16 v[88:91], a[136:139], a[92:95], v[88:91]
    v_mfma_f32_16x16x32_bf16 v[92:95], a[140:143], a[92:95], v[92:95]
    s_waitcnt vmcnt(4)
    v_mfma_f32_16x16x32_bf16 v[80:83], a[144:147], a[96:99], v[80:83]
    v_mfma_f32_16x16x32_bf16 v[84:87], a[148:151], a[96:99], v[84:87]
    v_mfma_f32_16x16x32_bf16 v[88:91], a[152:155], a[96:99], v[88:91]
    v_mfma_f32_16x16x32_bf16 v[92:95], a[156:159], a[96:99], v[92:95]
    s_waitcnt vmcnt(3)
    v_mfma_f32_16x16x32_bf16 v[80:83], a[160:163], a[100:103], v[80:83]
    v_mfma_f32_16x16x32_bf16 v[84:87], a[164:167], a[100:103], v[84:87]
    v_mfma_f32_16x16x32_bf16 v[88:91], a[168:171], a[100:103], v[88:91]
    v_mfma_f32_16x16x32_bf16 v[92:95], a[172:175], a[100:103], v[92:95]
    s_waitcnt vmcnt(2)
    v_mfma_f32_16x16x32_bf16 v[80:83], a[176:179], a[104:107], v[80:83]
    v_mfma_f32_16x16x32_bf16 v[84:87], a[180:183], a[104:107], v[84:87]
    v_mfma_f32_16x16x32_bf16 v[88:91], a[184:187], a[104:107], v[88:91]
    v_mfma_f32_16x16x32_bf16 v[92:95], a[188:191], a[104:107], v[92:95]
    s_waitcnt vmcnt(1)
    v_mfma_f32_16x16x32_bf16 v[80:83], a[192:195], a[108:111], v[80:83]
    v_mfma_f32_16x16x32_bf16 v[84:87], a[196:199], a[108:111], v[84:87]
    v_mfma_f32_16x16x32_bf16 v[88:91], a[200:203], a[108:111], v[88:91]
    v_mfma_f32_16x16x32_bf16 v[92:95], a[204:207], a[108:111], v[92:95]
    s_nop 4
    ds_write_b128 v8, v[80:83] offset:52224
    ds_write_b128 v8, v[84:87] offset:52288
    ds_write_b128 v8, v[88:91] offset:52352
    ds_write_b128 v8, v[92:95] offset:52416
    s_waitcnt lgkmcnt(0)
    s_barrier
    ds_read_b128 v[48:51], v28 offset:52224
    ds_read_b128 v[52:55], v28 offset:56576
    ds_read_b128 v[56:59], v28 offset:60928
    ds_read_b128 v[60:63], v28 offset:65280
    s_waitcnt lgkmcnt(2)
    v_pk_add_f32 v[48:49], v[48:49], v[52:53]
    v_pk_add_f32 v[50:51], v[50:51], v[54:55]
    s_waitcnt lgkmcnt(0)
    v_pk_add_f32 v[56:57], v[56:57], v[60:61]
    v_pk_add_f32 v[58:59], v[58:59], v[62:63]
    v_pk_add_f32 v[48:49], v[48:49], v[56:57]
    v_pk_add_f32 v[50:51], v[50:51], v[58:59]
    v_pk_fma_f32 v[48:49], v[48:49], v[100:101], v[116:117]
    v_pk_fma_f32 v[50:51], v[50:51], v[102:103], v[118:119]
    v_cvt_pk_bf16_f32 v116, v48, v49
    v_cvt_pk_bf16_f32 v117, v50, v51
    buffer_store_dwordx2 v[116:117], v31, s[40:43], s61 offen sc1
    s_cmp_lg_u32 s2, 0
    s_cbranch_scc1 L_noepoch
    v_lshlrev_b32 v4, 25, v0
    v_lshrrev_b32 v5, 7, v0
    v_lshl_or_b32 v4, v5, 25, v4
    buffer_store_dwordx2 v[14:15], v4, s[16:19], 0 offen sc1
L_noepoch:
    s_endpgm
L_stubs:
retry_2:
    s_nop 7
    s_mov_b32 s57, 16
poll_39:
    buffer_load_dwordx4 v[56:59], v23, s[16:19], 0 offen offset:2048 sc1
    s_waitcnt vmcnt(0)
    v_cmp_ne_u64 vcc, s[46:47], v[58:59]
    s_cbranch_vccz pollend_40
    s_sleep 1
    s_sub_u32 s57, s57, 1
    s_cbranch_scc0 poll_39
pollend_40:
    s_branch back_3
retry_5:
    s_nop 7
    s_mov_b32 s57, 131072
poll_41:
    buffer_load_dwordx4 v[144:147], v9, s[16:19], s24 offen offset:0 sc1
    buffer_load_dwordx4 v[148:151], v9, s[16:19], s24 offen offset:1024 sc1
    buffer_load_dwordx4 v[152:155], v9, s[16:19], s24 offen offset:2048 sc1
    buffer_load_dwordx4 v[156:159], v9, s[16:19], s24 offen offset:3072 sc1
    s_waitcnt vmcnt(0)
    v_cmp_ne_u64 vcc, s[46:47], v[146:147]
    v_cmp_ne_u64 s[72:73], s[46:47], v[150:151]
    v_cmp_ne_u64 s[74:75], s[46:47], v[154:155]
    s_or_b64 vcc, vcc, s[72:73]
    v_cmp_ne_u64 s[76:77], s[46:47], v[158:159]
    s_or_b64 vcc, vcc, s[74:75]
    s_or_b64 vcc, vcc, s[76:77]
    s_cbranch_vccz pollend_42
    s_sleep 1
    s_sub_u32 s57, s57, 1
    s_cbranch_scc0 poll_41
pollend_42:
    s_branch back_6
retry_7:
    s_nop 7
    s_mov_b32 s57, 131072
poll_43:
    buffer_load_dwordx4 v[88:91], v8, s[16:19], s23 offen sc1
    s_waitcnt vmcnt(0)
    v_cmp_ne_u64 vcc, s[46:47], v[90:91]
    s_cbranch_vccz pollend_44
    s_sleep 1
    s_sub_u32 s57, s57, 1
    s_cbranch_scc0 poll_43
pollend_44:
    s_branch back_8
retry_14:
    s_nop 7
    s_mov_b32 s57, 131072
poll_45:
    buffer_load_dwordx4 v[96:99], v2, s[16:19], 0 offen sc1
    s_waitcnt vmcnt(0)
    v_cmp_ne_u64 vcc, s[46:47], v[98:99]
    s_cbranch_vccz pollend_46
    s_sleep 1
    s_sub_u32 s57, s57, 1
    s_cbranch_scc0 poll_45
pollend_46:
    s_branch back_15
retry_17:
    s_nop 7
    s_mov_b32 s57, 131072
poll_47:
    buffer_load_dwordx4 v[52:55], v2, s[16:19], s88 offen sc1
    s_waitcnt vmcnt(0)
    v_cmp_ne_u64 vcc, s[46:47], v[54:55]
    s_cbranch_vccz pollend_48
    s_sleep 1
    s_sub_u32 s57, s57, 1
    s_cbranch_scc0 poll_47
pollend_48:
    s_branch back_18
retry_19:
    s_nop 7
    s_mov_b32 s57, 131072
poll_49:
    buffer_load_dwordx4 v[48:51], v30, s[16:19], s25 offen sc1
    s_waitcnt vmcnt(0)
    v_cmp_ne_u64 vcc, s[46:47], v[50:51]
    s_cbranch_vccz pollend_50
    s_sleep 1
    s_sub_u32 s57, s57, 1
    s_cbranch_scc0 poll_49
pollend_50:
    s_branch back_20
retry_21:
    s_nop 7
    s_mov_b32 s57, 131072
poll_51:
    buffer_load_dwordx4 v[4:7], v24, s[16:19], s20 offen offset:0 sc1
    s_waitcnt vmcnt(0)
    v_cmp_ne_u64 vcc, s[46:47], v[6:7]
    s_cbranch_vccz pollend_52
    s_sleep 1
    s_sub_u32 s57, s57, 1
    s_cbranch_scc0 poll_51
pollend_52:
    s_branch back_22
retry_24:
    s_nop 7
    s_mov_b32 s57, 131072
poll_53:
    buffer_load_dwordx4 v[4:7], v24, s[16:19], s20 offen offset:1024 sc1
    s_waitcnt vmcnt(0)
    v_cmp_ne_u64 vcc, s[46:47], v[6:7]
    s_cbranch_vccz pollend_54
    s_sleep 1
    s_sub_u32 s57, s57, 1
    s_cbranch_scc0 poll_53
pollend_54:
    s_branch back_25
retry_27:
    s_nop 7
    s_mov_b32 s57, 131072
poll_55:
    buffer_load_dwordx4 v[124:127], v26, s[16:19], s64 offen offset:0 sc1
    s_waitcnt vmcnt(0)
    v_cmp_ne_u64 vcc, s[46:47], v[126:127]
    s_cbranch_vccz pollend_56
    s_sleep 1
    s_sub_u32 s57, s57, 1
    s_cbranch_scc0 poll_55
pollend_56:
    s_branch back_28
retry_29:
    s_nop 7
    s_mov_b32 s57, 131072
poll_57:
    buffer_load_dwordx4 v[100:103], v25, s[16:19], s68 offen sc1
    s_waitcnt vmcnt(0)
    v_cmp_ne_u64 vcc, s[46:47], v[102:103]
    s_cbranch_vccz pollend_58
    s_sleep 1
    s_sub_u32 s57, s57, 1
    s_cbranch_scc0 poll_57
pollend_58:
    s_branch back_30
retry_31:
    s_nop 7
    s_mov_b32 s57, 131072
poll_59:
    buffer_load_dwordx4 v[124:127], v26, s[16:19], s64 offen offset:128 sc1
    s_waitcnt vmcnt(0)
    v_cmp_ne_u64 vcc, s[46:47], v[126:127]
    s_cbranch_vccz pollend_60
    s_sleep 1
    s_sub_u32 s57, s57, 1
    s_cbranch_scc0 poll_59
pollend_60:
    s_branch back_32
retry_35:
    s_nop 7
    s_mov_b32 s57, 131072
poll_61:
    buffer_load_dwordx4 v[124:127], v26, s[16:19], s64 offen offset:256 sc1
    s_waitcnt vmcnt(0)
    v_cmp_ne_u64 vcc, s[46:47], v[126:127]
    s_cbranch_vccz pollend_62
    s_sleep 1
    s_sub_u32 s57, s57, 1
    s_cbranch_scc0 poll_61
pollend_62:
    s_branch back_36
retry_37:
    s_nop 7
    s_mov_b32 s57, 131072
poll_63:
    buffer_load_dwordx4 v[124:127], v26, s[16:19], s64 offen offset:384 sc1
    s_waitcnt vmcnt(0)
    v_cmp_ne_u64 vcc, s[46:47], v[126:127]
    s_cbranch_vccz pollend_64
    s_sleep 1
    s_sub_u32 s57, s57, 1
    s_cbranch_scc0 poll_63
pollend_64:
    s_branch back_38
L_helper:
    s_load_dwordx2 s[12:13], s[0:1], 0
    s_mov_b32 s14, 1835008
    s_mov_b32 s15, 0x20000
    s_mov_b32 s18, 11763712
    s_mov_b32 s19, 0x20000
    s_lshl_b32 s60, s49, 5
    s_add_u32 s59, s59, s60
    s_mov_b32 s56, 0xffff0000
    s_load_dwordx2 s[32:33], s[0:1], 80
    s_mov_b32 s34, 896
    s_mov_b32 s35, 0x20000
    s_load_dwordx2 s[40:41], s[0:1], 88
    s_mov_b32 s42, 2408448
    s_mov_b32 s43, 0x20000
    s_load_dwordx2 s[36:37], s[0:1], 72
    s_mov_b32 s38, 1605632
    s_mov_b32 s39, 0x20000
    s_lshr_b32 s54, s49, 1
    s_lshl_b32 s54, s54, 2
    s_add_u32 s54, s54, s51
    s_cmp_ge_u32 s54, 7
    s_cselect_b32 s26, 1, 0
    s_cselect_b32 s60, 64, 56
    s_load_dwordx2 s[28:29], s[0:1], s60
    s_mov_b32 s30, 1605632
    s_mov_b32 s31, 0x20000
    s_and_b32 s60, s49, 1
    s_sub_u32 s60, s60, s26
    s_mul_i32 s60, s60, 7
    s_add_u32 s27, s60, s54
    s_and_b32 s60, s49, 1
    s_lshl1_add_u32 s52, s54, s60
    s_add_u32 s60, s52, 7
    s_sub_u32 s61, s52, 7
    s_cmp_lt_u32 s52, 28
    s_cselect_b32 s60, s60, s61
    s_cmp_lt_u32 s52, 21
    s_cselect_b32 s20, s52, s60
    s_sub_u32 s60, s52, 3
    s_cmp_lt_u32 s52, 31
    s_cselect_b32 s21, s60, 35
    v_bfe_u32 v10, v0, 2, 3
    v_mul_u32_u24 v10, 5376, v10
    v_bfe_u32 v2, v0, 5, 1
    v_lshl_add_u32 v10, v2, 6, v10
    v_and_b32 v2, 3, v0
    v_lshl_add_u32 v10, v2, 4, v10
    s_mul_i32 s60, s48, 602112
    v_add_u32 v10, s60, v10
    v_lshlrev_b32 v3, 1, v0
    s_mul_i32 s22, s48, 14336
    v_lshrrev_b32 v6, 5, v0
    s_lshl_b32 s60, s59, 3
    v_add_u32 v6, s60, v6
    v_mul_u32_u24 v6, 896, v6
    v_and_b32 v84, 31, v0
    v_lshl_add_u32 v6, v84, 4, v6
    v_cmp_gt_u32 vcc, 28, v84
    v_mov_b32 v84, 2147483392
    s_nop 0
    v_cndmask_b32 v6, v84, v6, vcc
    v_and_b32 v24, 63, v0
    v_lshlrev_b32 v24, 4, v24
    s_waitcnt lgkmcnt(0)
    buffer_load_ushort v32, v3, s[32:35], 0 offen
    buffer_load_ushort v33, v3, s[32:35], 0 offen offset:512
    s_load_dwordx2 s[46:47], s[16:17], 0
    buffer_load_dwordx4 v[84:87], v6, s[12:15], 0 offen
    buffer_load_dwordx4 v[88:91], v6, s[12:15], 0 offen offset:448
    s_lshl_b32 s60, s2, 7
    v_mov_b32 v23, s60
    buffer_load_dword v1, v23, s[16:19], 0 offen
    s_lshl_b32 s62, s20, 7
    s_add_u32 m0, s22, 0
    s_add_u32 s61, s62, 0
    buffer_load_dwordx4 v10, s[40:43], s61 offen lds
    s_add_u32 m0, s22, 1024
    s_add_u32 s61, s62, 43008
    buffer_load_dwordx4 v10, s[40:43], s61 offen lds
    s_add_u32 m0, s22, 2048
    s_add_u32 s61, s62, 86016
    buffer_load_dwordx4 v10, s[40:43], s61 offen lds
    s_add_u32 m0, s22, 3072
    s_add_u32 s61, s62, 129024
    buffer_load_dwordx4 v10, s[40:43], s61 offen lds
    s_add_u32 m0, s22, 4096
    s_add_u32 s61, s62, 172032
    buffer_load_dwordx4 v10, s[40:43], s61 offen lds
    s_add_u32 m0, s22, 5120
    s_add_u32 s61, s62, 215040
    buffer_load_dwordx4 v10, s[40:43], s61 offen lds
    s_add_u32 m0, s22, 6144
    s_add_u32 s61, s62, 258048
    buffer_load_dwordx4 v10, s[40:43], s61 offen lds
    s_add_u32 m0, s22, 7168
    s_add_u32 s61, s62, 301056
    buffer_load_dwordx4 v10, s[40:43], s61 offen lds
    s_add_u32 m0, s22, 8192
    s_add_u32 s61, s62, 344064
    buffer_load_dwordx4 v10, s[40:43], s61 offen lds
    s_add_u32 m0, s22, 9216
    s_add_u32 s61, s62, 387072
    buffer_load_dwordx4 v10, s[40:43], s61 offen lds
    s_add_u32 m0, s22, 10240
    s_add_u32 s61, s62, 430080
    buffer_load_dwordx4 v10, s[40:43], s61 offen lds
    s_add_u32 m0, s22, 11264
    s_add_u32 s61, s62, 473088
    buffer_load_dwordx4 v10, s[40:43], s61 offen lds
    s_add_u32 m0, s22, 12288
    s_add_u32 s61, s62, 516096
    buffer_load_dwordx4 v10, s[40:43], s61 offen lds
    s_add_u32 m0, s22, 13312
    s_add_u32 s61, s62, 559104
    buffer_load_dwordx4 v10, s[40:43], s61 offen lds
    s_waitcnt vmcnt(17)
    v_lshlrev_b32 v32, 16, v32
    v_mul_f32 v34, 0xbfb8aa3b, v32
    v_exp_f32 v34, v34
    s_nop 0
    v_add_f32 v34, 1.0, v34
    v_rcp_f32 v34, v34
    s_nop 0
    v_mul_f32 v32, v32, v34
    v_cvt_pk_bf16_f32 v32, v32, v32
    v_lshlrev_b32 v33, 16, v33
    v_mul_f32 v34, 0xbfb8aa3b, v33
    v_exp_f32 v34, v34
    s_nop 0
    v_add_f32 v34, 1.0, v34
    v_rcp_f32 v34, v34
    s_nop 0
    v_mul_f32 v33, v33, v34
    v_cvt_pk_bf16_f32 v33, v33, v33
    v_add_u32 v3, 114688, v3
    s_waitcnt lgkmcnt(0)
    ds_write_b16 v3, v32
    ds_write_b16 v3, v33 offset:512
    s_add_u32 s46, s46, 0x7f4a7c15
    s_addc_u32 s47, s47, 0x9e3779b9
    v_mov_b32 v14, s46
    v_mov_b32 v15, s47
    v_lshrrev_b32 v27, 2, v0
    v_lshlrev_b32 v27, 25, v27
    v_and_or_b32 v27, v24, 63, v27
    s_lshl_b32 s59, s59, 6
    s_add_u32 s59, s59, 4096
    v_mov_b32 v162, s46
    v_mov_b32 v163, s47
    v_mov_b32 v166, s46
    v_mov_b32 v167, s47
    v_bfe_u32 v4, v0, 2, 2
    v_bfe_u32 v2, v0, 5, 1
    v_mad_u32_u24 v4, v2, 4, v4
    v_lshlrev_b32 v4, 6, v4
    v_bfe_u32 v2, v0, 4, 1
    v_lshl_add_u32 v4, v2, 5, v4
    v_and_b32 v2, 3, v0
    v_lshl_add_u32 v4, v2, 3, v4
    v_add_u32 v4, s22, v4
    v_bfe_u32 v5, v0, 5, 1
    s_mul_i32 s60, s48, 224
    s_add_u32 s60, s60, 114688
    v_lshl_add_u32 v5, v5, 3, s60
    v_lshlrev_b32 v7, 2, v0
    v_add_u32 v7, 116736, v7
    v_and_b32 v8, 15, v0
    v_lshlrev_b32 v8, 4, v8
    v_lshrrev_b32 v9, 4, v0
    v_lshl_or_b32 v9, v9, 25, v8
    v_add_u32 v8, 116736, v8
    s_waitcnt vmcnt(15)
    s_mov_b32 s61, 0x3f803f80
    v_mov_b32 v160, 0
    v_mov_b32 v161, 0
    v_dot2c_f32_bf16 v160, s61, v84
    v_dot2c_f32_bf16 v161, v84, v84
    v_dot2c_f32_bf16 v160, s61, v85
    v_dot2c_f32_bf16 v161, v85, v85
    v_dot2c_f32_bf16 v160, s61, v86
    v_dot2c_f32_bf16 v161, v86, v86
    v_dot2c_f32_bf16 v160, s61, v87
    v_dot2c_f32_bf16 v161, v87, v87
    v_dot2c_f32_bf16 v160, s61, v88
    v_dot2c_f32_bf16 v161, v88, v88
    v_dot2c_f32_bf16 v160, s61, v89
    v_dot2c_f32_bf16 v161, v89, v89
    v_dot2c_f32_bf16 v160, s61, v90
    v_dot2c_f32_bf16 v161, v90, v90
    v_dot2c_f32_bf16 v160, s61, v91
    v_dot2c_f32_bf16 v161, v91, v91
    s_nop 1
    v_add_f32_dpp v160, v160, v160 quad_perm:[1,0,3,2] row_mask:0xf bank_mask:0xf
    v_add_f32_dpp v161, v161, v161 quad_perm:[1,0,3,2] row_mask:0xf bank_mask:0xf
    s_nop 0
    v_add_f32_dpp v160, v160, v160 quad_perm:[2,3,0,1] row_mask:0xf bank_mask:0xf
    v_add_f32_dpp v161, v161, v161 quad_perm:[2,3,0,1] row_mask:0xf bank_mask:0xf
    s_nop 0
    v_add_f32_dpp v160, v160, v160 row_half_mirror row_mask:0xf bank_mask:0xf
    v_add_f32_dpp v161, v161, v161 row_half_mirror row_mask:0xf bank_mask:0xf
    s_nop 0
    v_add_f32_dpp v160, v160, v160 row_mirror row_mask:0xf bank_mask:0xf
    v_add_f32_dpp v161, v161, v161 row_mirror row_mask:0xf bank_mask:0xf
    v_mov_b32 v84, v160
    v_mov_b32 v85, v161
    s_nop 0
    v_permlane16_swap_b32 v160, v84
    v_permlane16_swap_b32 v161, v85
    v_add_f32 v160, v160, v84
    v_add_f32 v161, v161, v85
    v_mul_f32 v160, 0x3b124925, v160
    v_mul_f32 v161, 0x3b124925, v161
    v_fma_f32 v161, -v160, v160, v161
    v_max_f32 v161, 0, v161
    v_cvt_pk_bf16_f32 v161, v161, v161
    v_lshlrev_b32 v161, 16, v161
    v_add_f32 v161, 0x3727c5ac, v161
    v_cvt_pk_bf16_f32 v161, v161, v161
    v_lshlrev_b32 v161, 16, v161
    v_sqrt_f32 v161, v161
    s_nop 0
    v_cvt_pk_bf16_f32 v160, v160, v161
    v_lshrrev_b32 v161, 5, v0
    v_lshlrev_b32 v161, 2, v161
    v_add_u32 v161, 159360, v161
    ds_write_b32 v161, v160
    v_and_b32 v84, 3, v0
    v_lshlrev_b32 v84, 3, v84
    v_add_u32 v84, 159360, v84
    s_waitcnt lgkmcnt(0)
    s_barrier
    ds_read_b64 v[12:13], v84
    s_waitcnt lgkmcnt(0)
    s_cmp_lg_u32 s48, 0
    s_cbranch_scc1 noflag_65
    buffer_store_dwordx4 v[12:15], v27, s[16:19], s59 offen offset:0 sc1
noflag_65:
    ds_read_b64 v[96:97], v5 offset:0
    ds_read_b64 v[98:99], v5 offset:16
    ds_read_b64 v[100:101], v5 offset:32
    ds_read_b64 v[102:103], v5 offset:48
    ds_read_b64 v[104:105], v5 offset:64
    ds_read_b64 v[106:107], v5 offset:80
    ds_read_b64 v[108:109], v5 offset:96
    ds_read_b64 v[110:111], v5 offset:112
    ds_read_b64 v[112:113], v5 offset:128
    ds_read_b64 v[114:115], v5 offset:144
    ds_read_b64 v[116:117], v5 offset:160
    ds_read_b64 v[118:119], v5 offset:176
    ds_read_b64 v[120:121], v5 offset:192
    ds_read_b64 v[122:123], v5 offset:208
    s_cmp_lt_u32 s52, 28
    s_cbranch_scc1 L_h_one
L_h_again:
    s_lshl_b32 s62, s21, 7
    s_add_u32 m0, s22, 57344
    s_add_u32 s61, s62, 0
    buffer_load_dwordx4 v10, s[40:43], s61 offen lds
    s_add_u32 m0, s22, 58368
    s_add_u32 s61, s62, 43008
    buffer_load_dwordx4 v10, s[40:43], s61 offen lds
    s_add_u32 m0, s22, 59392
    s_add_u32 s61, s62, 86016
    buffer_load_dwordx4 v10, s[40:43], s61 offen lds
    s_add_u32 m0, s22, 60416
    s_add_u32 s61, s62, 129024
    buffer_load_dwordx4 v10, s[40:43], s61 offen lds
    s_add_u32 m0, s22, 61440
    s_add_u32 s61, s62, 172032
    buffer_load_dwordx4 v10, s[40:43], s61 offen lds
    s_add_u32 m0, s22, 62464
    s_add_u32 s61, s62, 215040
    buffer_load_dwordx4 v10, s[40:43], s61 offen lds
    s_add_u32 m0, s22, 63488
    s_add_u32 s61, s62, 258048
    buffer_load_dwordx4 v10, s[40:43], s61 offen lds
    s_add_u32 m0, s22, 64512
    s_add_u32 s61, s62, 301056
    buffer_load_dwordx4 v10, s[40:43], s61 offen lds
    s_add_u32 m0, s22, 65536
    s_add_u32 s61, s62, 344064
    buffer_load_dwordx4 v10, s[40:43], s61 offen lds
    s_add_u32 m0, s22, 66560
    s_add_u32 s61, s62, 387072
    buffer_load_dwordx4 v10, s[40:43], s61 offen lds
    s_add_u32 m0, s22, 67584
    s_add_u32 s61, s62, 430080
    buffer_load_dwordx4 v10, s[40:43], s61 offen lds
    s_add_u32 m0, s22, 68608
    s_add_u32 s61, s62, 473088
    buffer_load_dwordx4 v10, s[40:43], s61 offen lds
    s_add_u32 m0, s22, 69632
    s_add_u32 s61, s62, 516096
    buffer_load_dwordx4 v10, s[40:43], s61 offen lds
    s_add_u32 m0, s22, 70656
    s_add_u32 s61, s62, 559104
    buffer_load_dwordx4 v10, s[40:43], s61 offen lds
    s_waitcnt vmcnt(14)
    s_branch L_h_go
L_h_one:
    s_waitcnt vmcnt(0)
L_h_go:
    ds_read_b64_tr_b16 v[32:33], v4 offset:0
    ds_read_b64_tr_b16 v[34:35], v4 offset:1024
    ds_read_b64_tr_b16 v[36:37], v4 offset:512
    ds_read_b64_tr_b16 v[38:39], v4 offset:1536
    ds_read_b64_tr_b16 v[40:41], v4 offset:2048
    ds_read_b64_tr_b16 v[42:43], v4 offset:3072
    ds_read_b64_tr_b16 v[44:45], v4 offset:2560
    ds_read_b64_tr_b16 v[46:47], v4 offset:3584
    ds_read_b64_tr_b16 v[48:49], v4 offset:4096
    ds_read_b64_tr_b16 v[50:51], v4 offset:5120
    ds_read_b64_tr_b16 v[52:53], v4 offset:4608
    ds_read_b64_tr_b16 v[54:55], v4 offset:5632
    ds_read_b64_tr_b16 v[56:57], v4 offset:6144
    ds_read_b64_tr_b16 v[58:59], v4 offset:7168
    ds_read_b64_tr_b16 v[60:61], v4 offset:6656
    ds_read_b64_tr_b16 v[62:63], v4 offset:7680
    ds_read_b64_tr_b16 v[64:65], v4 offset:8192
    ds_read_b64_tr_b16 v[66:67], v4 offset:9216
    ds_read_b64_tr_b16 v[68:69], v4 offset:8704
    ds_read_b64_tr_b16 v[70:71], v4 offset:9728
    ds_read_b64_tr_b16 v[72:73], v4 offset:10240
    ds_read_b64_tr_b16 v[74:75], v4 offset:11264
    ds_read_b64_tr_b16 v[76:77], v4 offset:10752
    ds_read_b64_tr_b16 v[78:79], v4 offset:11776
    ds_read_b64_tr_b16 v[80:81], v4 offset:12288
    ds_read_b64_tr_b16 v[82:83], v4 offset:13312
    ds_read_b64_tr_b16 v[84:85], v4 offset:12800
    ds_read_b64_tr_b16 v[86:87], v4 offset:13824
    s_waitcnt lgkmcnt(15)
    v_mfma_f32_32x32x16_bf16 v[128:143], v[96:99], v[32:35], 0
    v_mfma_f32_32x32x16_bf16 v[144:159], v[96:99], v[36:39], 0
    v_mfma_f32_32x32x16_bf16 v[128:143], v[100:103], v[40:43], v[128:143]
    v_mfma_f32_32x32x16_bf16 v[144:159], v[100:103], v[44:47], v[144:159]
    v_mfma_f32_32x32x16_bf16 v[128:143], v[104:107], v[48:51], v[128:143]
    v_mfma_f32_32x32x16_bf16 v[144:159], v[104:107], v[52:55], v[144:159]
    s_waitcnt lgkmcnt(12)
    v_mfma_f32_32x32x16_bf16 v[128:143], v[108:111], v[56:59], v[128:143]
    v_mfma_f32_32x32x16_bf16 v[144:159], v[108:111], v[60:63], v[144:159]
    s_waitcnt lgkmcnt(8)
    v_mfma_f32_32x32x16_bf16 v[128:143], v[112:115], v[64:67], v[128:143]
    v_mfma_f32_32x32x16_bf16 v[144:159], v[112:115], v[68:71], v[144:159]
    s_waitcnt lgkmcnt(4)
    v_mfma_f32_32x32x16_bf16 v[128:143], v[116:119], v[72:75], v[128:143]
    v_mfma_f32_32x32x16_bf16 v[144:159], v[116:119], v[76:79], v[144:159]
    s_waitcnt lgkmcnt(0)
    v_mfma_f32_32x32x16_bf16 v[128:143], v[120:123], v[80:83], v[128:143]
    v_mfma_f32_32x32x16_bf16 v[144:159], v[120:123], v[84:87], v[144:159]
    v_and_b32 v2, 32, v0
    v_cmp_eq_u32 vcc, 0, v2
    s_nop 9
    v_cndmask_b32 v2, v144, v128, vcc
    ds_write_b32 v7, v2 offset:0
    s_waitcnt lgkmcnt(0)
    s_barrier
    ds_read_b128 v[32:35], v8 offset:0
    ds_read_b128 v[36:39], v8 offset:256
    ds_read_b128 v[40:43], v8 offset:512
    ds_read_b128 v[44:47], v8 offset:768
    s_waitcnt lgkmcnt(0)
    v_pk_add_f32 v[32:33], v[32:33], v[36:37]
    v_pk_add_f32 v[34:35], v[34:35], v[38:39]
    v_pk_add_f32 v[32:33], v[32:33], v[40:41]
    v_pk_add_f32 v[34:35], v[34:35], v[42:43]
    v_pk_add_f32 v[32:33], v[32:33], v[44:45]
    v_pk_add_f32 v[34:35], v[34:35], v[46:47]
    v_cvt_pk_bf16_f32 v164, v32, v33
    v_cvt_pk_bf16_f32 v165, v34, v35
    s_lshl_b32 s60, s20, 8
    s_add_u32 s60, s60, 20480
    buffer_store_dwordx4 v[164:167], v9, s[16:19], s60 offen sc1
    s_cmp_lt_u32 s52, 28
    s_cbranch_scc1 L_h_two
    v_add_u32 v4, 57344, v4
    s_waitcnt vmcnt(0)
    ds_read_b64_tr_b16 v[32:33], v4 offset:0
    ds_read_b64_tr_b16 v[34:35], v4 offset:1024
    ds_read_b64_tr_b16 v[36:37], v4 offset:512
    ds_read_b64_tr_b16 v[38:39], v4 offset:1536
    ds_read_b64_tr_b16 v[40:41], v4 offset:2048
    ds_read_b64_tr_b16 v[42:43], v4 offset:3072
    ds_read_b64_tr_b16 v[44:45], v4 offset:2560
    ds_read_b64_tr_b16 v[46:47], v4 offset:3584
    ds_read_b64_tr_b16 v[48:49], v4 offset:4096
    ds_read_b64_tr_b16 v[50:51], v4 offset:5120
    ds_read_b64_tr_b16 v[52:53], v4 offset:4608
    ds_read_b64_tr_b16 v[54:55], v4 offset:5632
    ds_read_b64_tr_b16 v[56:57], v4 offset:6144
    ds_read_b64_tr_b16 v[58:59], v4 offset:7168
    ds_read_b64_tr_b16 v[60:61], v4 offset:6656
    ds_read_b64_tr_b16 v[62:63], v4 offset:7680
    ds_read_b64_tr_b16 v[64:65], v4 offset:8192
    ds_read_b64_tr_b16 v[66:67], v4 offset:9216
    ds_read_b64_tr_b16 v[68:69], v4 offset:8704
    ds_read_b64_tr_b16 v[70:71], v4 offset:9728
    ds_read_b64_tr_b16 v[72:73], v4 offset:10240
    ds_read_b64_tr_b16 v[74:75], v4 offset:11264
    ds_read_b64_tr_b16 v[76:77], v4 offset:10752
    ds_read_b64_tr_b16 v[78:79], v4 offset:11776
    ds_read_b64_tr_b16 v[80:81], v4 offset:12288
    ds_read_b64_tr_b16 v[82:83], v4 offset:13312
    ds_read_b64_tr_b16 v[84:85], v4 offset:12800
    ds_read_b64_tr_b16 v[86:87], v4 offset:13824
    s_waitcnt lgkmcnt(15)
    v_mfma_f32_32x32x16_bf16 v[128:143], v[96:99], v[32:35], 0
    v_mfma_f32_32x32x16_bf16 v[144:159], v[96:99], v[36:39], 0
    v_mfma_f32_32x32x16_bf16 v[128:143], v[100:103], v[40:43], v[128:143]
    v_mfma_f32_32x32x16_bf16 v[144:159], v[100:103], v[44:47], v[144:159]
    v_mfma_f32_32x32x16_bf16 v[128:143], v[104:107], v[48:51], v[128:143]
    v_mfma_f32_32x32x16_bf16 v[144:159], v[104:107], v[52:55], v[144:159]
    s_waitcnt lgkmcnt(12)
    v_mfma_f32_32x32x16_bf16 v[128:143], v[108:111], v[56:59], v[128:143]
    v_mfma_f32_32x32x16_bf16 v[144:159], v[108:111], v[60:63], v[144:159]
    s_waitcnt lgkmcnt(8)
    v_mfma_f32_32x32x16_bf16 v[128:143], v[112:115], v[64:67], v[128:143]
    v_mfma_f32_32x32x16_bf16 v[144:159], v[112:115], v[68:71], v[144:159]
    s_waitcnt lgkmcnt(4)
    v_mfma_f32_32x32x16_bf16 v[128:143], v[116:119], v[72:75], v[128:143]
    v_mfma_f32_32x32x16_bf16 v[144:159], v[116:119], v[76:79], v[144:159]
    s_waitcnt lgkmcnt(0)
    v_mfma_f32_32x32x16_bf16 v[128:143], v[120:123], v[80:83], v[128:143]
    v_mfma_f32_32x32x16_bf16 v[144:159], v[120:123], v[84:87], v[144:159]
    v_and_b32 v2, 32, v0
    v_cmp_eq_u32 vcc, 0, v2
    s_nop 9
    v_cndmask_b32 v2, v144, v128, vcc
    ds_write_b32 v7, v2 offset:1024
    s_waitcnt lgkmcnt(0)
    s_barrier
    ds_read_b128 v[32:35], v8 offset:1024
    ds_read_b128 v[36:39], v8 offset:1280
    ds_read_b128 v[40:43], v8 offset:1536
    ds_read_b128 v[44:47], v8 offset:1792
    s_waitcnt lgkmcnt(0)
    v_pk_add_f32 v[32:33], v[32:33], v[36:37]
    v_pk_add_f32 v[34:35], v[34:35], v[38:39]
    v_pk_add_f32 v[32:33], v[32:33], v[40:41]
    v_pk_add_f32 v[34:35], v[34:35], v[42:43]
    v_pk_add_f32 v[32:33], v[32:33], v[44:45]
    v_pk_add_f32 v[34:35], v[34:35], v[46:47]
    v_cvt_pk_bf16_f32 v164, v32, v33
    v_cvt_pk_bf16_f32 v165, v34, v35
    s_lshl_b32 s60, s21, 8
    s_add_u32 s60, s60, 20480
    buffer_store_dwordx4 v[164:167], v9, s[16:19], s60 offen sc1
    v_subrev_u32 v4, 57344, v4
    s_cmp_ge_u32 s20, 36
    s_cbranch_scc1 L_h_two
    s_add_u32 s20, s52, 8
    s_add_u32 s21, s52, 12
    s_min_u32 s21, s21, 41
    s_lshl_b32 s62, s20, 7
    s_add_u32 m0, s22, 0
    s_add_u32 s61, s62, 0
    buffer_load_dwordx4 v10, s[40:43], s61 offen lds
    s_add_u32 m0, s22, 1024
    s_add_u32 s61, s62, 43008
    buffer_load_dwordx4 v10, s[40:43], s61 offen lds
    s_add_u32 m0, s22, 2048
    s_add_u32 s61, s62, 86016
    buffer_load_dwordx4 v10, s[40:43], s61 offen lds
    s_add_u32 m0, s22, 3072
    s_add_u32 s61, s62, 129024
    buffer_load_dwordx4 v10, s[40:43], s61 offen lds
    s_add_u32 m0, s22, 4096
    s_add_u32 s61, s62, 172032
    buffer_load_dwordx4 v10, s[40:43], s61 offen lds
    s_add_u32 m0, s22, 5120
    s_add_u32 s61, s62, 215040
    buffer_load_dwordx4 v10, s[40:43], s61 offen lds
    s_add_u32 m0, s22, 6144
    s_add_u32 s61, s62, 258048
    buffer_load_dwordx4 v10, s[40:43], s61 offen lds
    s_add_u32 m0, s22, 7168
    s_add_u32 s61, s62, 301056
    buffer_load_dwordx4 v10, s[40:43], s61 offen lds
    s_add_u32 m0, s22, 8192
    s_add_u32 s61, s62, 344064
    buffer_load_dwordx4 v10, s[40:43], s61 offen lds
    s_add_u32 m0, s22, 9216
    s_add_u32 s61, s62, 387072
    buffer_load_dwordx4 v10, s[40:43], s61 offen lds
    s_add_u32 m0, s22, 10240
    s_add_u32 s61, s62, 430080
    buffer_load_dwordx4 v10, s[40:43], s61 offen lds
    s_add_u32 m0, s22, 11264
    s_add_u32 s61, s62, 473088
    buffer_load_dwordx4 v10, s[40:43], s61 offen lds
    s_add_u32 m0, s22, 12288
    s_add_u32 s61, s62, 516096
    buffer_load_dwordx4 v10, s[40:43], s61 offen lds
    s_add_u32 m0, s22, 13312
    s_add_u32 s61, s62, 559104
    buffer_load_dwordx4 v10, s[40:43], s61 offen lds
    s_branch L_h_again
L_h_two:
    v_bfe_u32 v11, v0, 2, 2
    v_bfe_u32 v2, v0, 5, 1
    v_mad_u32_u24 v11, v2, 8, v11
    v_lshlrev_b32 v11, 6, v11
    v_bfe_u32 v2, v0, 4, 1
    v_lshl_add_u32 v11, v2, 5, v11
    v_and_b32 v2, 3, v0
    v_lshl_add_u32 v11, v2, 3, v11
    v_bfe_u32 v10, v0, 2, 4
    v_mul_u32_u24 v10, 3584, v10
    v_and_b32 v2, 3, v0
    s_lshl_b32 s60, s27, 2
    s_add_u32 s63, s60, s48
    s_lshl_b32 s60, s63, 6
    v_lshl_add_u32 v2, v2, 4, s60
    v_add_u32 v10, v10, v2
    s_mul_i32 s62, s48, 28672
    v_add_u32 v4, s62, v11
    s_cmp_ge_u32 s54, 14
    s_cbranch_scc1 L_h_nodma
    s_add_u32 m0, s62, 0
    s_mov_b32 s61, 0
    buffer_load_dwordx4 v10, s[28:31], s61 offen lds
    s_add_u32 m0, s62, 1024
    s_mov_b32 s61, 57344
    buffer_load_dwordx4 v10, s[28:31], s61 offen lds
    s_add_u32 m0, s62, 2048
    s_mov_b32 s61, 114688
    buffer_load_dwordx4 v10, s[28:31], s61 offen lds
    s_add_u32 m0, s62, 3072
    s_mov_b32 s61, 172032
    buffer_load_dwordx4 v10, s[28:31], s61 offen lds
    s_add_u32 m0, s62, 4096
    s_mov_b32 s61, 229376
    buffer_load_dwordx4 v10, s[28:31], s61 offen lds
    s_add_u32 m0, s62, 5120
    s_mov_b32 s61, 286720
    buffer_load_dwordx4 v10, s[28:31], s61 offen lds
    s_add_u32 m0, s62, 6144
    s_mov_b32 s61, 344064
    buffer_load_dwordx4 v10, s[28:31], s61 offen lds
    s_add_u32 m0, s62, 7168
    s_mov_b32 s61, 401408
    buffer_load_dwordx4 v10, s[28:31], s61 offen lds
    s_add_u32 m0, s62, 8192
    s_mov_b32 s61, 458752
    buffer_load_dwordx4 v10, s[28:31], s61 offen lds
    s_add_u32 m0, s62, 9216
    s_mov_b32 s61, 516096
    buffer_load_dwordx4 v10, s[28:31], s61 offen lds
    s_add_u32 m0, s62, 10240
    s_mov_b32 s61, 573440
    buffer_load_dwordx4 v10, s[28:31], s61 offen lds
    s_add_u32 m0, s62, 11264
    s_mov_b32 s61, 630784
    buffer_load_dwordx4 v10, s[28:31], s61 offen lds
    s_add_u32 m0, s62, 12288
    s_mov_b32 s61, 688128
    buffer_load_dwordx4 v10, s[28:31], s61 offen lds
    s_add_u32 m0, s62, 13312
    s_mov_b32 s61, 745472
    buffer_load_dwordx4 v10, s[28:31], s61 offen lds
    s_add_u32 m0, s62, 14336
    s_mov_b32 s61, 802816
    buffer_load_dwordx4 v10, s[28:31], s61 offen lds
    s_add_u32 m0, s62, 15360
    s_mov_b32 s61, 860160
    buffer_load_dwordx4 v10, s[28:31], s61 offen lds
    s_add_u32 m0, s62, 16384
    s_mov_b32 s61, 917504
    buffer_load_dwordx4 v10, s[28:31], s61 offen lds
    s_add_u32 m0, s62, 17408
    s_mov_b32 s61, 974848
    buffer_load_dwordx4 v10, s[28:31], s61 offen lds
    s_add_u32 m0, s62, 18432
    s_mov_b32 s61, 1032192
    buffer_load_dwordx4 v10, s[28:31], s61 offen lds
    s_add_u32 m0, s62, 19456
    s_mov_b32 s61, 1089536
    buffer_load_dwordx4 v10, s[28:31], s61 offen lds
    s_add_u32 m0, s62, 20480
    s_mov_b32 s61, 1146880
    buffer_load_dwordx4 v10, s[28:31], s61 offen lds
    s_add_u32 m0, s62, 21504
    s_mov_b32 s61, 1204224
    buffer_load_dwordx4 v10, s[28:31], s61 offen lds
    s_add_u32 m0, s62, 22528
    s_mov_b32 s61, 1261568
    buffer_load_dwordx4 v10, s[28:31], s61 offen lds
    s_add_u32 m0, s62, 23552
    s_mov_b32 s61, 1318912
    buffer_load_dwordx4 v10, s[28:31], s61 offen lds
    s_add_u32 m0, s62, 24576
    s_mov_b32 s61, 1376256
    buffer_load_dwordx4 v10, s[28:31], s61 offen lds
    s_add_u32 m0, s62, 25600
    s_mov_b32 s61, 1433600
    buffer_load_dwordx4 v10, s[28:31], s61 offen lds
    s_add_u32 m0, s62, 26624
    s_mov_b32 s61, 1490944
    buffer_load_dwordx4 v10, s[28:31], s61 offen lds
    s_add_u32 m0, s62, 27648
    s_mov_b32 s61, 1548288
    buffer_load_dwordx4 v10, s[28:31], s61 offen lds
L_h_nodma:
    v_min_u32 v2, 223, v0
    v_lshlrev_b32 v3, 4, v2
    s_mov_b32 s68, 25856
    s_mov_b32 s57, 131072
poll_66:
    buffer_load_dwordx4 v[32:35], v3, s[16:19], s68 offen sc1
    s_waitcnt vmcnt(0)
    v_cmp_ne_u64 vcc, s[46:47], v[34:35]
    s_cbranch_vccz pollend_67
    s_sleep 4
    s_sub_u32 s57, s57, 1
    s_cbranch_scc0 poll_66
pollend_67:
    s_cmp_ge_u32 s54, 14
    s_cbranch_scc1 L_h_nord
    s_lshl2_add_u32 s60, s52, s48
    s_mulk_i32 s60, 14336
    v_min_u32 v26, 880, v24
    v_lshl_add_u32 v26, v26, 3, s60
    s_movk_i32 s60, 7168
    buffer_load_dword v1, v26, s[36:39], 0 offen
    buffer_load_dword v1, v26, s[36:39], s60 offen
    ds_read_b64_tr_b16 a[0:1], v4 offset:0
    ds_read_b64_tr_b16 a[2:3], v4 offset:256
    ds_read_b64_tr_b16 a[4:5], v4 offset:1024
    ds_read_b64_tr_b16 a[6:7], v4 offset:1280
    ds_read_b64_tr_b16 a[8:9], v4 offset:2048
    ds_read_b64_tr_b16 a[10:11], v4 offset:2304
    ds_read_b64_tr_b16 a[12:13], v4 offset:3072
    ds_read_b64_tr_b16 a[14:15], v4 offset:3328
    ds_read_b64_tr_b16 a[16:17], v4 offset:4096
    ds_read_b64_tr_b16 a[18:19], v4 offset:4352
    ds_read_b64_tr_b16 a[20:21], v4 offset:5120
    ds_read_b64_tr_b16 a[22:23], v4 offset:5376
    ds_read_b64_tr_b16 a[24:25], v4 offset:6144
    ds_read_b64_tr_b16 a[26:27], v4 offset:6400
    ds_read_b64_tr_b16 a[28:29], v4 offset:7168
    ds_read_b64_tr_b16 a[30:31], v4 offset:7424
    ds_read_b64_tr_b16 a[32:33], v4 offset:8192
    ds_read_b64_tr_b16 a[34:35], v4 offset:8448
    ds_read_b64_tr_b16 a[36:37], v4 offset:9216
    ds_read_b64_tr_b16 a[38:39], v4 offset:9472
    ds_read_b64_tr_b16 a[40:41], v4 offset:10240
    ds_read_b64_tr_b16 a[42:43], v4 offset:10496
    ds_read_b64_tr_b16 a[44:45], v4 offset:11264
    ds_read_b64_tr_b16 a[46:47], v4 offset:11520
    ds_read_b64_tr_b16 a[48:49], v4 offset:12288
    ds_read_b64_tr_b16 a[50:51], v4 offset:12544
    ds_read_b64_tr_b16 a[52:53], v4 offset:13312
    ds_read_b64_tr_b16 a[54:55], v4 offset:13568
    ds_read_b64_tr_b16 a[56:57], v4 offset:14336
    ds_read_b64_tr_b16 a[58:59], v4 offset:14592
    ds_read_b64_tr_b16 a[60:61], v4 offset:15360
    ds_read_b64_tr_b16 a[62:63], v4 offset:15616
    ds_read_b64_tr_b16 a[64:65], v4 offset:16384
    ds_read_b64_tr_b16 a[66:67], v4 offset:16640
    ds_read_b64_tr_b16 a[68:69], v4 offset:17408
    ds_read_b64_tr_b16 a[70:71], v4 offset:17664
    ds_read_b64_tr_b16 a[72:73], v4 offset:18432
    ds_read_b64_tr_b16 a[74:75], v4 offset:18688
    ds_read_b64_tr_b16 a[76:77], v4 offset:19456
    ds_read_b64_tr_b16 a[78:79], v4 offset:19712
    ds_read_b64_tr_b16 a[80:81], v4 offset:20480
    ds_read_b64_tr_b16 a[82:83], v4 offset:20736
    ds_read_b64_tr_b16 a[84:85], v4 offset:21504
    ds_read_b64_tr_b16 a[86:87], v4 offset:21760
    ds_read_b64_tr_b16 a[88:89], v4 offset:22528
    ds_read_b64_tr_b16 a[90:91], v4 offset:22784
    ds_read_b64_tr_b16 a[92:93], v4 offset:23552
    ds_read_b64_tr_b16 a[94:95], v4 offset:23808
    ds_read_b64_tr_b16 a[96:97], v4 offset:24576
    ds_read_b64_tr_b16 a[98:99], v4 offset:24832
    ds_read_b64_tr_b16 a[100:101], v4 offset:25600
    ds_read_b64_tr_b16 a[102:103], v4 offset:25856
    ds_read_b64_tr_b16 a[104:105], v4 offset:26624
    ds_read_b64_tr_b16 a[106:107], v4 offset:26880
    ds_read_b64_tr_b16 a[108:109], v4 offset:27648
    ds_read_b64_tr_b16 a[110:111], v4 offset:27904
L_h_nord:
    v_cmp_le_u32 vcc, 112, v2
    s_nop 1
    v_cndmask_b32 v5, 0, 1.0, vcc
    v_lshlrev_b32 v36, 16, v32
    v_add_f32 v36, v5, v36
    v_and_b32 v37, s56, v32
    v_add_f32 v37, v5, v37
    v_lshlrev_b32 v38, 16, v33
    v_add_f32 v38, v5, v38
    v_and_b32 v39, s56, v33
    v_add_f32 v39, v5, v39
    v_cvt_pk_bf16_f32 v32, v36, v37
    v_cvt_pk_bf16_f32 v33, v38, v39
    v_mov_b32 v5, 0x2b800000
    v_cndmask_b32 v5, 0, v5, vcc
    v_lshlrev_b32 v36, 16, v32
    v_cmp_eq_f32 vcc, 0, v36
    s_nop 1
    v_cndmask_b32 v36, v36, v5, vcc
    v_rcp_f32 v40, v36
    v_and_b32 v37, s56, v32
    v_cmp_eq_f32 vcc, 0, v37
    s_nop 1
    v_cndmask_b32 v37, v37, v5, vcc
    v_rcp_f32 v41, v37
    v_lshlrev_b32 v38, 16, v33
    v_cmp_eq_f32 vcc, 0, v38
    s_nop 1
    v_cndmask_b32 v38, v38, v5, vcc
    v_rcp_f32 v42, v38
    v_and_b32 v39, s56, v33
    v_cmp_eq_f32 vcc, 0, v39
    s_nop 1
    v_cndmask_b32 v39, v39, v5, vcc
    v_rcp_f32 v43, v39
    v_cvt_pk_bf16_f32 v32, v36, v37
    v_cvt_pk_bf16_f32 v33, v38, v39
    v_add_u32 v3, 120832, v3
    ds_write_b128 v3, v[40:43]
    v_lshlrev_b32 v2, 3, v2
    v_add_u32 v2, 157312, v2
    ds_write_b64 v2, v[32:33]
    v_and_b32 v2, 1, v0
    v_mul_u32_u24 v2, 896, v2
    v_bfe_u32 v3, v0, 5, 1
    v_lshlrev_b32 v5, 4, v3
    v_sub_u32 v2, v5, v2
    v_add_u32 v2, 158208, v2
    v_lshl_or_b32 v3, v3, 25, v24
    s_lshl_b32 s63, s63, 9
    s_mul_i32 s60, s26, 28672
    s_add_u32 s63, s63, s60
    s_add_u32 s63, s63, 65536
    s_mul_i32 s60, s48, 448
    s_add_u32 s60, s60, 122624
    v_lshl_add_u32 v5, v5, 1, s60
    s_waitcnt lgkmcnt(0)
    s_barrier
    ds_read_b128 v[192:195], v5 offset:0
    ds_read_b128 v[196:199], v5 offset:16
    ds_read_b128 v[200:203], v5 offset:64
    ds_read_b128 v[204:207], v5 offset:80
    ds_read_b128 v[208:211], v5 offset:128
    ds_read_b128 v[212:215], v5 offset:144
    ds_read_b128 v[216:219], v5 offset:192
    ds_read_b128 v[220:223], v5 offset:208
    ds_read_b128 v[224:227], v5 offset:256
    ds_read_b128 v[228:231], v5 offset:272
    ds_read_b128 v[232:235], v5 offset:320
    ds_read_b128 v[236:239], v5 offset:336
    ds_read_b128 v[240:243], v5 offset:384
    ds_read_b128 v[244:247], v5 offset:400
    s_waitcnt lgkmcnt(0)
    s_cmp_ge_u32 s54, 14
    s_cbranch_scc1 L_h_nout
    ds_read_b128 a[112:115], v2 offset:0
    ds_read_b128 a[116:119], v2 offset:32
    ds_read_b128 a[120:123], v2 offset:64
    ds_read_b128 a[124:127], v2 offset:96
    ds_read_b128 a[128:131], v2 offset:128
    ds_read_b128 a[132:135], v2 offset:160
    ds_read_b128 a[136:139], v2 offset:192
    ds_read_b128 a[140:143], v2 offset:224
    ds_read_b128 a[144:147], v2 offset:256
    ds_read_b128 a[148:151], v2 offset:288
    ds_read_b128 a[152:155], v2 offset:320
    ds_read_b128 a[156:159], v2 offset:352
    ds_read_b128 a[160:163], v2 offset:384
    ds_read_b128 a[164:167], v2 offset:416
    ds_read_b128 a[168:171], v2 offset:448
    ds_read_b128 a[172:175], v2 offset:480
    ds_read_b128 a[176:179], v2 offset:512
    ds_read_b128 a[180:183], v2 offset:544
    ds_read_b128 a[184:187], v2 offset:576
    ds_read_b128 a[188:191], v2 offset:608
    ds_read_b128 a[192:195], v2 offset:640
    ds_read_b128 a[196:199], v2 offset:672
    ds_read_b128 a[200:203], v2 offset:704
    ds_read_b128 a[204:207], v2 offset:736
    ds_read_b128 a[208:211], v2 offset:768
    ds_read_b128 a[212:215], v2 offset:800
    ds_read_b128 a[216:219], v2 offset:832
    ds_read_b128 a[220:223], v2 offset:864
    s_waitcnt lgkmcnt(15)
    v_mfma_f32_32x32x16_bf16 v[128:143], a[112:115], a[0:3], 0
    v_mfma_f32_32x32x16_bf16 v[128:143], a[116:119], a[4:7], v[128:143]
    v_mfma_f32_32x32x16_bf16 v[128:143], a[120:123], a[8:11], v[128:143]
    v_mfma_f32_32x32x16_bf16 v[128:143], a[124:127], a[12:15], v[128:143]
    v_mfma_f32_32x32x16_bf16 v[128:143], a[128:131], a[16:19], v[128:143]
    v_mfma_f32_32x32x16_bf16 v[128:143], a[132:135], a[20:23], v[128:143]
    v_mfma_f32_32x32x16_bf16 v[128:143], a[136:139], a[24:27], v[128:143]
    v_mfma_f32_32x32x16_bf16 v[128:143], a[140:143], a[28:31], v[128:143]
    v_mfma_f32_32x32x16_bf16 v[128:143], a[144:147], a[32:35], v[128:143]
    v_mfma_f32_32x32x16_bf16 v[128:143], a[148:151], a[36:39], v[128:143]
    v_mfma_f32_32x32x16_bf16 v[128:143], a[152:155], a[40:43], v[128:143]
    v_mfma_f32_32x32x16_bf16 v[128:143], a[156:159], a[44:47], v[128:143]
    v_mfma_f32_32x32x16_bf16 v[128:143], a[160:163], a[48:51], v[128:143]
    s_waitcnt lgkmcnt(14)
    v_mfma_f32_32x32x16_bf16 v[128:143], a[164:167], a[52:55], v[128:143]
    s_waitcnt lgkmcnt(13)
    v_mfma_f32_32x32x16_bf16 v[128:143], a[168:171], a[56:59], v[128:143]
    s_waitcnt lgkmcnt(12)
    v_mfma_f32_32x32x16_bf16 v[128:143], a[172:175], a[60:63], v[128:143]
    s_waitcnt lgkmcnt(11)
    v_mfma_f32_32x32x16_bf16 v[128:143], a[176:179], a[64:67], v[128:143]
    s_waitcnt lgkmcnt(10)
    v_mfma_f32_32x32x16_bf16 v[128:143], a[180:183], a[68:71], v[128:143]
    s_waitcnt lgkmcnt(9)
    v_mfma_f32_32x32x16_bf16 v[128:143], a[184:187], a[72:75], v[128:143]
    s_waitcnt lgkmcnt(8)
    v_mfma_f32_32x32x16_bf16 v[128:143], a[188:191], a[76:79], v[128:143]
    s_waitcnt lgkmcnt(7)
    v_mfma_f32_32x32x16_bf16 v[128:143], a[192:195], a[80:83], v[128:143]
    s_waitcnt lgkmcnt(6)
    v_mfma_f32_32x32x16_bf16 v[128:143], a[196:199], a[84:87], v[128:143]
    s_waitcnt lgkmcnt(5)
    v_mfma_f32_32x32x16_bf16 v[128:143], a[200:203], a[88:91], v[128:143]
    s_waitcnt lgkmcnt(4)
    v_mfma_f32_32x32x16_bf16 v[128:143], a[204:207], a[92:95], v[128:143]
    s_waitcnt lgkmcnt(3)
    v_mfma_f32_32x32x16_bf16 v[128:143], a[208:211], a[96:99], v[128:143]
    s_waitcnt lgkmcnt(2)
    v_mfma_f32_32x32x16_bf16 v[128:143], a[212:215], a[100:103], v[128:143]
    s_waitcnt lgkmcnt(1)
    v_mfma_f32_32x32x16_bf16 v[128:143], a[216:219], a[104:107], v[128:143]
    s_waitcnt lgkmcnt(0)
    v_mfma_f32_32x32x16_bf16 v[128:143], a[220:223], a[108:111], v[128:143]
    s_nop 11
    v_cvt_pk_bf16_f32 v164, v128, v129
    v_lshlrev_b32 v2, 16, v164
    v_and_b32 v5, s56, v164
    v_sub_f32 v2, v128, v2
    v_sub_f32 v5, v129, v5
    v_cvt_pk_bf16_f32 v165, v2, v5
    buffer_store_dwordx4 v[164:167], v3, s[16:19], s63 offen sc1
L_h_nout:
    s_barrier
    s_mul_i32 s65, s48, 7168
    v_add_u32 v11, s65, v11
    v_bfe_u32 v25, v0, 3, 3
    v_mul_u32_u24 v25, 16896, v25
    v_and_b32 v5, 7, v0
    v_lshl_add_u32 v25, v5, 4, v25
    s_lshl_b32 s23, s54, 2
    s_and_b32 s60, s49, 1
    s_add_u32 s23, s23, s60
    s_mul_i32 s60, s48, 946176
    s_lshl_b32 s61, s23, 7
    s_add_u32 s60, s60, s61
    s_add_u32 s4, s60, 393216
    s_add_u32 s5, s60, 528384
    s_add_u32 s6, s60, 663552
    s_add_u32 s7, s60, 798720
    s_add_u32 s8, s60, 933888
    s_add_u32 s9, s60, 1069056
    s_add_u32 s10, s60, 1204224
    s_lshl_b32 s23, s23, 9
    s_add_u32 s23, s23, 32768
    v_and_b32 v8, 31, v0
    v_lshrrev_b32 v9, 5, v0
    v_lshlrev_b32 v2, 4, v8
    v_lshl_or_b32 v9, v9, 25, v2
    v_lshlrev_b32 v8, 2, v8
    v_add_u32 v8, 116736, v8
    s_mov_b32 s25, 0x3f803f80
    v_min_u32 v2, 880, v24
    s_mul_i32 s60, s48, 3584
    s_add_u32 s60, s60, 122880
    v_lshl_add_u32 v2, v2, 2, s60
    s_lshl_b32 s61, s52, 6
    s_add_u32 s60, s60, s61
    v_mov_b32 v3, s60
    v_mov_b32 v22, v2
    v_mov_b32 v23, v3
    s_mov_b32 s88, 49152
    v_min_u32 v26, 880, v24
    v_lshl_add_u32 v26, v26, 3, s65
    s_lshr_b32 s60, s51, 1
    s_mul_i32 s82, s60, 802816
    s_add_u32 s83, s82, 802816
    s_and_b32 s60, s51, 1
    s_mul_i32 s60, s60, 57344
    s_add_u32 s82, s82, s60
    s_mov_b32 s84, 28672
    s_mov_b32 s57, 131072
poll_68:
    buffer_load_dwordx4 v[32:35], v23, s[16:19], 0 offen sc1
    s_waitcnt vmcnt(0)
    v_cmp_ne_u64 vcc, s[46:47], v[34:35]
    s_cbranch_vccz pollend_69
    s_sleep 6
    s_sub_u32 s57, s57, 1
    s_cbranch_scc0 poll_68
pollend_69:
    s_mov_b32 s57, 131072
poll_70:
    buffer_load_dwordx4 v[32:35], v22, s[16:19], 0 offen sc1
    s_waitcnt vmcnt(0)
    v_cmp_ne_u64 vcc, s[46:47], v[34:35]
    s_cbranch_vccz pollend_71
    s_sleep 2
    s_sub_u32 s57, s57, 1
    s_cbranch_scc0 poll_70
pollend_71:
    s_add_u32 m0, s65, 0
    s_nop 0
    buffer_load_dwordx4 v25, s[16:19], s4 offen offset:0 sc1 lds
    s_add_u32 m0, s65, 1024
    s_nop 0
    buffer_load_dwordx4 v25, s[16:19], s5 offen offset:0 sc1 lds
    s_add_u32 m0, s65, 2048
    s_nop 0
    buffer_load_dwordx4 v25, s[16:19], s6 offen offset:0 sc1 lds
    s_add_u32 m0, s65, 3072
    s_nop 0
    buffer_load_dwordx4 v25, s[16:19], s7 offen offset:0 sc1 lds
    s_add_u32 m0, s65, 4096
    s_nop 0
    buffer_load_dwordx4 v25, s[16:19], s8 offen offset:0 sc1 lds
    s_add_u32 m0, s65, 5120
    s_nop 0
    buffer_load_dwordx4 v25, s[16:19], s9 offen offset:0 sc1 lds
    s_add_u32 m0, s65, 6144
    s_nop 0
    buffer_load_dwordx4 v25, s[16:19], s10 offen offset:0 sc1 lds
    s_waitcnt vmcnt(0)
    ds_read_b64_tr_b16 v[64:65], v11 offset:0
    ds_read_b64_tr_b16 v[66:67], v11 offset:256
    ds_read_b64_tr_b16 v[68:69], v11 offset:1024
    ds_read_b64_tr_b16 v[70:71], v11 offset:1280
    ds_read_b64_tr_b16 v[72:73], v11 offset:2048
    ds_read_b64_tr_b16 v[74:75], v11 offset:2304
    ds_read_b64_tr_b16 v[76:77], v11 offset:3072
    ds_read_b64_tr_b16 v[78:79], v11 offset:3328
    ds_read_b64_tr_b16 v[80:81], v11 offset:4096
    ds_read_b64_tr_b16 v[82:83], v11 offset:4352
    ds_read_b64_tr_b16 v[84:85], v11 offset:5120
    ds_read_b64_tr_b16 v[86:87], v11 offset:5376
    ds_read_b64_tr_b16 v[88:89], v11 offset:6144
    ds_read_b64_tr_b16 v[90:91], v11 offset:6400
    v_mov_b32 v48, 0
    v_mov_b32 v49, 0
    v_mov_b32 v50, 0
    v_mov_b32 v51, 0
    v_mov_b32 v52, 0
    v_mov_b32 v53, 0
    v_mov_b32 v54, 0
    v_mov_b32 v55, 0
    s_waitcnt lgkmcnt(12)
    v_lshlrev_b32 v40, 16, v64
    v_and_b32 v41, s56, v64
    v_lshlrev_b32 v42, 16, v65
    v_and_b32 v43, s56, v65
    v_lshlrev_b32 v44, 16, v66
    v_and_b32 v45, s56, v66
    v_lshlrev_b32 v46, 16, v67
    v_and_b32 v47, s56, v67
    v_pk_mul_f32 v[40:41], v[40:41], v[192:193]
    v_pk_mul_f32 v[42:43], v[42:43], v[194:195]
    v_pk_mul_f32 v[44:45], v[44:45], v[196:197]
    v_pk_mul_f32 v[46:47], v[46:47], v[198:199]
    v_pk_add_f32 v[48:49], v[48:49], v[40:41]
    v_pk_fma_f32 v[50:51], v[40:41], v[40:41], v[50:51]
    v_pk_add_f32 v[52:53], v[52:53], v[42:43]
    v_pk_fma_f32 v[54:55], v[42:43], v[42:43], v[54:55]
    v_pk_add_f32 v[48:49], v[48:49], v[44:45]
    v_pk_fma_f32 v[50:51], v[44:45], v[44:45], v[50:51]
    v_pk_add_f32 v[52:53], v[52:53], v[46:47]
    v_pk_fma_f32 v[54:55], v[46:47], v[46:47], v[54:55]
    s_waitcnt lgkmcnt(10)
    v_lshlrev_b32 v40, 16, v68
    v_and_b32 v41, s56, v68
    v_lshlrev_b32 v42, 16, v69
    v_and_b32 v43, s56, v69
    v_lshlrev_b32 v44, 16, v70
    v_and_b32 v45, s56, v70
    v_lshlrev_b32 v46, 16, v71
    v_and_b32 v47, s56, v71
    v_pk_mul_f32 v[40:41], v[40:41], v[200:201]
    v_pk_mul_f32 v[42:43], v[42:43], v[202:203]
    v_pk_mul_f32 v[44:45], v[44:45], v[204:205]
    v_pk_mul_f32 v[46:47], v[46:47], v[206:207]
    v_pk_add_f32 v[48:49], v[48:49], v[40:41]
    v_pk_fma_f32 v[50:51], v[40:41], v[40:41], v[50:51]
    v_pk_add_f32 v[52:53], v[52:53], v[42:43]
    v_pk_fma_f32 v[54:55], v[42:43], v[42:43], v[54:55]
    v_pk_add_f32 v[48:49], v[48:49], v[44:45]
    v_pk_fma_f32 v[50:51], v[44:45], v[44:45], v[50:51]
    v_pk_add_f32 v[52:53], v[52:53], v[46:47]
    v_pk_fma_f32 v[54:55], v[46:47], v[46:47], v[54:55]
    s_waitcnt lgkmcnt(8)
    v_lshlrev_b32 v40, 16, v72
    v_and_b32 v41, s56, v72
    v_lshlrev_b32 v42, 16, v73
    v_and_b32 v43, s56, v73
    v_lshlrev_b32 v44, 16, v74
    v_and_b32 v45, s56, v74
    v_lshlrev_b32 v46, 16, v75
    v_and_b32 v47, s56, v75
    v_pk_mul_f32 v[40:41], v[40:41], v[208:209]
    v_pk_mul_f32 v[42:43], v[42:43], v[210:211]
    v_pk_mul_f32 v[44:45], v[44:45], v[212:213]
    v_pk_mul_f32 v[46:47], v[46:47], v[214:215]
    v_pk_add_f32 v[48:49], v[48:49], v[40:41]
    v_pk_fma_f32 v[50:51], v[40:41], v[40:41], v[50:51]
    v_pk_add_f32 v[52:53], v[52:53], v[42:43]
    v_pk_fma_f32 v[54:55], v[42:43], v[42:43], v[54:55]
    v_pk_add_f32 v[48:49], v[48:49], v[44:45]
    v_pk_fma_f32 v[50:51], v[44:45], v[44:45], v[50:51]
    v_pk_add_f32 v[52:53], v[52:53], v[46:47]
    v_pk_fma_f32 v[54:55], v[46:47], v[46:47], v[54:55]
    s_waitcnt lgkmcnt(6)
    v_lshlrev_b32 v40, 16, v76
    v_and_b32 v41, s56, v76
    v_lshlrev_b32 v42, 16, v77
    v_and_b32 v43, s56, v77
    v_lshlrev_b32 v44, 16, v78
    v_and_b32 v45, s56, v78
    v_lshlrev_b32 v46, 16, v79
    v_and_b32 v47, s56, v79
    v_pk_mul_f32 v[40:41], v[40:41], v[216:217]
    v_pk_mul_f32 v[42:43], v[42:43], v[218:219]
    v_pk_mul_f32 v[44:45], v[44:45], v[220:221]
    v_pk_mul_f32 v[46:47], v[46:47], v[222:223]
    v_pk_add_f32 v[48:49], v[48:49], v[40:41]
    v_pk_fma_f32 v[50:51], v[40:41], v[40:41], v[50:51]
    v_pk_add_f32 v[52:53], v[52:53], v[42:43]
    v_pk_fma_f32 v[54:55], v[42:43], v[42:43], v[54:55]
    v_pk_add_f32 v[48:49], v[48:49], v[44:45]
    v_pk_fma_f32 v[50:51], v[44:45], v[44:45], v[50:51]
    v_pk_add_f32 v[52:53], v[52:53], v[46:47]
    v_pk_fma_f32 v[54:55], v[46:47], v[46:47], v[54:55]
    s_waitcnt lgkmcnt(4)
    v_lshlrev_b32 v40, 16, v80
    v_and_b32 v41, s56, v80
    v_lshlrev_b32 v42, 16, v81
    v_and_b32 v43, s56, v81
    v_lshlrev_b32 v44, 16, v82
    v_and_b32 v45, s56, v82
    v_lshlrev_b32 v46, 16, v83
    v_and_b32 v47, s56, v83
    v_pk_mul_f32 v[40:41], v[40:41], v[224:225]
    v_pk_mul_f32 v[42:43], v[42:43], v[226:227]
    v_pk_mul_f32 v[44:45], v[44:45], v[228:229]
    v_pk_mul_f32 v[46:47], v[46:47], v[230:231]
    v_pk_add_f32 v[48:49], v[48:49], v[40:41]
    v_pk_fma_f32 v[50:51], v[40:41], v[40:41], v[50:51]
    v_pk_add_f32 v[52:53], v[52:53], v[42:43]
    v_pk_fma_f32 v[54:55], v[42:43], v[42:43], v[54:55]
    v_pk_add_f32 v[48:49], v[48:49], v[44:45]
    v_pk_fma_f32 v[50:51], v[44:45], v[44:45], v[50:51]
    v_pk_add_f32 v[52:53], v[52:53], v[46:47]
    v_pk_fma_f32 v[54:55], v[46:47], v[46:47], v[54:55]
    s_waitcnt lgkmcnt(2)
    v_lshlrev_b32 v40, 16, v84
    v_and_b32 v41, s56, v84
    v_lshlrev_b32 v42, 16, v85
    v_and_b32 v43, s56, v85
    v_lshlrev_b32 v44, 16, v86
    v_and_b32 v45, s56, v86
    v_lshlrev_b32 v46, 16, v87
    v_and_b32 v47, s56, v87
    v_pk_mul_f32 v[40:41], v[40:41], v[232:233]
    v_pk_mul_f32 v[42:43], v[42:43], v[234:235]
    v_pk_mul_f32 v[44:45], v[44:45], v[236:237]
    v_pk_mul_f32 v[46:47], v[46:47], v[238:239]
    v_pk_add_f32 v[48:49], v[48:49], v[40:41]
    v_pk_fma_f32 v[50:51], v[40:41], v[40:41], v[50:51]
    v_pk_add_f32 v[52:53], v[52:53], v[42:43]
    v_pk_fma_f32 v[54:55], v[42:43], v[42:43], v[54:55]
    v_pk_add_f32 v[48:49], v[48:49], v[44:45]
    v_pk_fma_f32 v[50:51], v[44:45], v[44:45], v[50:51]
    v_pk_add_f32 v[52:53], v[52:53], v[46:47]
    v_pk_fma_f32 v[54:55], v[46:47], v[46:47], v[54:55]
    s_waitcnt lgkmcnt(0)
    v_lshlrev_b32 v40, 16, v88
    v_and_b32 v41, s56, v88
    v_lshlrev_b32 v42, 16, v89
    v_and_b32 v43, s56, v89
    v_lshlrev_b32 v44, 16, v90
    v_and_b32 v45, s56, v90
    v_lshlrev_b32 v46, 16, v91
    v_and_b32 v47, s56, v91
    v_pk_mul_f32 v[40:41], v[40:41], v[240:241]
    v_pk_mul_f32 v[42:43], v[42:43], v[242:243]
    v_pk_mul_f32 v[44:45], v[44:45], v[244:245]
    v_pk_mul_f32 v[46:47], v[46:47], v[246:247]
    v_pk_add_f32 v[48:49], v[48:49], v[40:41]
    v_pk_fma_f32 v[50:51], v[40:41], v[40:41], v[50:51]
    v_pk_add_f32 v[52:53], v[52:53], v[42:43]
    v_pk_fma_f32 v[54:55], v[42:43], v[42:43], v[54:55]
    v_pk_add_f32 v[48:49], v[48:49], v[44:45]
    v_pk_fma_f32 v[50:51], v[44:45], v[44:45], v[50:51]
    v_pk_add_f32 v[52:53], v[52:53], v[46:47]
    v_pk_fma_f32 v[54:55], v[46:47], v[46:47], v[54:55]
    v_pk_add_f32 v[48:49], v[48:49], v[52:53]
    v_pk_add_f32 v[50:51], v[50:51], v[54:55]
    v_add_f32 v2, v48, v49
    v_add_f32 v3, v50, v51
    s_nop 1
    v_permlane32_swap_b32 v2, v3
    v_add_f32 v2, v2, v3
    ds_write_b32 v7, v2 offset:0
    s_waitcnt lgkmcnt(0)
    s_barrier
    ds_read_b32 v64, v8 offset:0
    ds_read_b32 v65, v8 offset:128
    ds_read_b32 v66, v8 offset:256
    ds_read_b32 v67, v8 offset:384
    ds_read_b32 v68, v8 offset:512
    ds_read_b32 v69, v8 offset:640
    ds_read_b32 v70, v8 offset:768
    ds_read_b32 v71, v8 offset:896
    s_waitcnt lgkmcnt(0)
    v_pk_add_f32 v[64:65], v[64:65], v[66:67]
    v_pk_add_f32 v[68:69], v[68:69], v[70:71]
    v_pk_add_f32 v[160:161], v[64:65], v[68:69]
    v_mul_f32 v160, 0x3b124925, v160
    v_mul_f32 v161, 0x3b124925, v161
    v_fma_f32 v161, -v160, v160, v161
    v_max_f32 v161, 0, v161
    v_add_f32 v161, 0x3727c5ac, v161
    v_sqrt_f32 v2, v161
    v_rcp_f32 v161, v161
    v_cvt_pk_bf16_f32 v160, -v160, v2
    buffer_store_dwordx4 v[160:163], v9, s[16:19], s23 offen offset:0 sc1
    s_mov_b32 s57, 131072
poll_72:
    buffer_load_dwordx4 v[32:35], v23, s[16:19], s88 offen sc1
    s_waitcnt vmcnt(0)
    v_cmp_ne_u64 vcc, s[46:47], v[34:35]
    s_cbranch_vccz pollend_73
    s_sleep 6
    s_sub_u32 s57, s57, 1
    s_cbranch_scc0 poll_72
pollend_73:
    s_mov_b32 s57, 131072
poll_74:
    buffer_load_dwordx4 v[32:35], v22, s[16:19], s88 offen sc1
    s_waitcnt vmcnt(0)
    v_cmp_ne_u64 vcc, s[46:47], v[34:35]
    s_cbranch_vccz pollend_75
    s_sleep 2
    s_sub_u32 s57, s57, 1
    s_cbranch_scc0 poll_74
pollend_75:
    s_add_u32 m0, s65, 28416
    s_nop 0
    buffer_load_dwordx4 v25, s[16:19], s4 offen offset:256 sc1 lds
    s_add_u32 m0, s65, 29440
    s_nop 0
    buffer_load_dwordx4 v25, s[16:19], s5 offen offset:256 sc1 lds
    s_add_u32 m0, s65, 30464
    s_nop 0
    buffer_load_dwordx4 v25, s[16:19], s6 offen offset:256 sc1 lds
    s_add_u32 m0, s65, 31488
    s_nop 0
    buffer_load_dwordx4 v25, s[16:19], s7 offen offset:256 sc1 lds
    s_add_u32 m0, s65, 32512
    s_nop 0
    buffer_load_dwordx4 v25, s[16:19], s8 offen offset:256 sc1 lds
    s_add_u32 m0, s65, 33536
    s_nop 0
    buffer_load_dwordx4 v25, s[16:19], s9 offen offset:256 sc1 lds
    s_add_u32 m0, s65, 34560
    s_nop 0
    buffer_load_dwordx4 v25, s[16:19], s10 offen offset:256 sc1 lds
    s_waitcnt vmcnt(0)
    ds_read_b64_tr_b16 v[64:65], v11 offset:28672
    ds_read_b64_tr_b16 v[66:67], v11 offset:28928
    ds_read_b64_tr_b16 v[68:69], v11 offset:29696
    ds_read_b64_tr_b16 v[70:71], v11 offset:29952
    ds_read_b64_tr_b16 v[72:73], v11 offset:30720
    ds_read_b64_tr_b16 v[74:75], v11 offset:30976
    ds_read_b64_tr_b16 v[76:77], v11 offset:31744
    ds_read_b64_tr_b16 v[78:79], v11 offset:32000
    ds_read_b64_tr_b16 v[80:81], v11 offset:32768
    ds_read_b64_tr_b16 v[82:83], v11 offset:33024
    ds_read_b64_tr_b16 v[84:85], v11 offset:33792
    ds_read_b64_tr_b16 v[86:87], v11 offset:34048
    ds_read_b64_tr_b16 v[88:89], v11 offset:34816
    ds_read_b64_tr_b16 v[90:91], v11 offset:35072
    v_mov_b32 v48, 0
    v_mov_b32 v49, 0
    v_mov_b32 v50, 0
    v_mov_b32 v51, 0
    v_mov_b32 v52, 0
    v_mov_b32 v53, 0
    v_mov_b32 v54, 0
    v_mov_b32 v55, 0
    s_waitcnt lgkmcnt(12)
    v_lshlrev_b32 v40, 16, v64
    v_and_b32 v41, s56, v64
    v_lshlrev_b32 v42, 16, v65
    v_and_b32 v43, s56, v65
    v_lshlrev_b32 v44, 16, v66
    v_and_b32 v45, s56, v66
    v_lshlrev_b32 v46, 16, v67
    v_and_b32 v47, s56, v67
    v_pk_mul_f32 v[40:41], v[40:41], v[192:193]
    v_pk_mul_f32 v[42:43], v[42:43], v[194:195]
    v_pk_mul_f32 v[44:45], v[44:45], v[196:197]
    v_pk_mul_f32 v[46:47], v[46:47], v[198:199]
    v_pk_add_f32 v[48:49], v[48:49], v[40:41]
    v_pk_fma_f32 v[50:51], v[40:41], v[40:41], v[50:51]
    v_pk_add_f32 v[52:53], v[52:53], v[42:43]
    v_pk_fma_f32 v[54:55], v[42:43], v[42:43], v[54:55]
    v_pk_add_f32 v[48:49], v[48:49], v[44:45]
    v_pk_fma_f32 v[50:51], v[44:45], v[44:45], v[50:51]
    v_pk_add_f32 v[52:53], v[52:53], v[46:47]
    v_pk_fma_f32 v[54:55], v[46:47], v[46:47], v[54:55]
    s_waitcnt lgkmcnt(10)
    v_lshlrev_b32 v40, 16, v68
    v_and_b32 v41, s56, v68
    v_lshlrev_b32 v42, 16, v69
    v_and_b32 v43, s56, v69
    v_lshlrev_b32 v44, 16, v70
    v_and_b32 v45, s56, v70
    v_lshlrev_b32 v46, 16, v71
    v_and_b32 v47, s56, v71
    v_pk_mul_f32 v[40:41], v[40:41], v[200:201]
    v_pk_mul_f32 v[42:43], v[42:43], v[202:203]
    v_pk_mul_f32 v[44:45], v[44:45], v[204:205]
    v_pk_mul_f32 v[46:47], v[46:47], v[206:207]
    v_pk_add_f32 v[48:49], v[48:49], v[40:41]
    v_pk_fma_f32 v[50:51], v[40:41], v[40:41], v[50:51]
    v_pk_add_f32 v[52:53], v[52:53], v[42:43]
    v_pk_fma_f32 v[54:55], v[42:43], v[42:43], v[54:55]
    v_pk_add_f32 v[48:49], v[48:49], v[44:45]
    v_pk_fma_f32 v[50:51], v[44:45], v[44:45], v[50:51]
    v_pk_add_f32 v[52:53], v[52:53], v[46:47]
    v_pk_fma_f32 v[54:55], v[46:47], v[46:47], v[54:55]
    s_waitcnt lgkmcnt(8)
    v_lshlrev_b32 v40, 16, v72
    v_and_b32 v41, s56, v72
    v_lshlrev_b32 v42, 16, v73
    v_and_b32 v43, s56, v73
    v_lshlrev_b32 v44, 16, v74
    v_and_b32 v45, s56, v74
    v_lshlrev_b32 v46, 16, v75
    v_and_b32 v47, s56, v75
    v_pk_mul_f32 v[40:41], v[40:41], v[208:209]
    v_pk_mul_f32 v[42:43], v[42:43], v[210:211]
    v_pk_mul_f32 v[44:45], v[44:45], v[212:213]
    v_pk_mul_f32 v[46:47], v[46:47], v[214:215]
    v_pk_add_f32 v[48:49], v[48:49], v[40:41]
    v_pk_fma_f32 v[50:51], v[40:41], v[40:41], v[50:51]
    v_pk_add_f32 v[52:53], v[52:53], v[42:43]
    v_pk_fma_f32 v[54:55], v[42:43], v[42:43], v[54:55]
    v_pk_add_f32 v[48:49], v[48:49], v[44:45]
    v_pk_fma_f32 v[50:51], v[44:45], v[44:45], v[50:51]
    v_pk_add_f32 v[52:53], v[52:53], v[46:47]
    v_pk_fma_f32 v[54:55], v[46:47], v[46:47], v[54:55]
    s_waitcnt lgkmcnt(6)
    v_lshlrev_b32 v40, 16, v76
    v_and_b32 v41, s56, v76
    v_lshlrev_b32 v42, 16, v77
    v_and_b32 v43, s56, v77
    v_lshlrev_b32 v44, 16, v78
    v_and_b32 v45, s56, v78
    v_lshlrev_b32 v46, 16, v79
    v_and_b32 v47, s56, v79
    v_pk_mul_f32 v[40:41], v[40:41], v[216:217]
    v_pk_mul_f32 v[42:43], v[42:43], v[218:219]
    v_pk_mul_f32 v[44:45], v[44:45], v[220:221]
    v_pk_mul_f32 v[46:47], v[46:47], v[222:223]
    v_pk_add_f32 v[48:49], v[48:49], v[40:41]
    v_pk_fma_f32 v[50:51], v[40:41], v[40:41], v[50:51]
    v_pk_add_f32 v[52:53], v[52:53], v[42:43]
    v_pk_fma_f32 v[54:55], v[42:43], v[42:43], v[54:55]
    v_pk_add_f32 v[48:49], v[48:49], v[44:45]
    v_pk_fma_f32 v[50:51], v[44:45], v[44:45], v[50:51]
    v_pk_add_f32 v[52:53], v[52:53], v[46:47]
    v_pk_fma_f32 v[54:55], v[46:47], v[46:47], v[54:55]
    s_waitcnt lgkmcnt(4)
    v_lshlrev_b32 v40, 16, v80
    v_and_b32 v41, s56, v80
    v_lshlrev_b32 v42, 16, v81
    v_and_b32 v43, s56, v81
    v_lshlrev_b32 v44, 16, v82
    v_and_b32 v45, s56, v82
    v_lshlrev_b32 v46, 16, v83
    v_and_b32 v47, s56, v83
    v_pk_mul_f32 v[40:41], v[40:41], v[224:225]
    v_pk_mul_f32 v[42:43], v[42:43], v[226:227]
    v_pk_mul_f32 v[44:45], v[44:45], v[228:229]
    v_pk_mul_f32 v[46:47], v[46:47], v[230:231]
    v_pk_add_f32 v[48:49], v[48:49], v[40:41]
    v_pk_fma_f32 v[50:51], v[40:41], v[40:41], v[50:51]
    v_pk_add_f32 v[52:53], v[52:53], v[42:43]
    v_pk_fma_f32 v[54:55], v[42:43], v[42:43], v[54:55]
    v_pk_add_f32 v[48:49], v[48:49], v[44:45]
    v_pk_fma_f32 v[50:51], v[44:45], v[44:45], v[50:51]
    v_pk_add_f32 v[52:53], v[52:53], v[46:47]
    v_pk_fma_f32 v[54:55], v[46:47], v[46:47], v[54:55]
    s_waitcnt lgkmcnt(2)
    v_lshlrev_b32 v40, 16, v84
    v_and_b32 v41, s56, v84
    v_lshlrev_b32 v42, 16, v85
    v_and_b32 v43, s56, v85
    v_lshlrev_b32 v44, 16, v86
    v_and_b32 v45, s56, v86
    v_lshlrev_b32 v46, 16, v87
    v_and_b32 v47, s56, v87
    v_pk_mul_f32 v[40:41], v[40:41], v[232:233]
    v_pk_mul_f32 v[42:43], v[42:43], v[234:235]
    v_pk_mul_f32 v[44:45], v[44:45], v[236:237]
    v_pk_mul_f32 v[46:47], v[46:47], v[238:239]
    v_pk_add_f32 v[48:49], v[48:49], v[40:41]
    v_pk_fma_f32 v[50:51], v[40:41], v[40:41], v[50:51]
    v_pk_add_f32 v[52:53], v[52:53], v[42:43]
    v_pk_fma_f32 v[54:55], v[42:43], v[42:43], v[54:55]
    v_pk_add_f32 v[48:49], v[48:49], v[44:45]
    v_pk_fma_f32 v[50:51], v[44:45], v[44:45], v[50:51]
    v_pk_add_f32 v[52:53], v[52:53], v[46:47]
    v_pk_fma_f32 v[54:55], v[46:47], v[46:47], v[54:55]
    s_waitcnt lgkmcnt(0)
    v_lshlrev_b32 v40, 16, v88
    v_and_b32 v41, s56, v88
    v_lshlrev_b32 v42, 16, v89
    v_and_b32 v43, s56, v89
    v_lshlrev_b32 v44, 16, v90
    v_and_b32 v45, s56, v90
    v_lshlrev_b32 v46, 16, v91
    v_and_b32 v47, s56, v91
    v_pk_mul_f32 v[40:41], v[40:41], v[240:241]
    v_pk_mul_f32 v[42:43], v[42:43], v[242:243]
    v_pk_mul_f32 v[44:45], v[44:45], v[244:245]
    v_pk_mul_f32 v[46:47], v[46:47], v[246:247]
    v_pk_add_f32 v[48:49], v[48:49], v[40:41]
    v_pk_fma_f32 v[50:51], v[40:41], v[40:41], v[50:51]
    v_pk_add_f32 v[52:53], v[52:53], v[42:43]
    v_pk_fma_f32 v[54:55], v[42:43], v[42:43], v[54:55]
    v_pk_add_f32 v[48:49], v[48:49], v[44:45]
    v_pk_fma_f32 v[50:51], v[44:45], v[44:45], v[50:51]
    v_pk_add_f32 v[52:53], v[52:53], v[46:47]
    v_pk_fma_f32 v[54:55], v[46:47], v[46:47], v[54:55]
    v_pk_add_f32 v[48:49], v[48:49], v[52:53]
    v_pk_add_f32 v[50:51], v[50:51], v[54:55]
    v_add_f32 v2, v48, v49
    v_add_f32 v3, v50, v51
    s_nop 1
    v_permlane32_swap_b32 v2, v3
    v_add_f32 v2, v2, v3
    ds_write_b32 v7, v2 offset:1024
    s_waitcnt lgkmcnt(0)
    s_barrier
    ds_read_b32 v64, v8 offset:1024
    ds_read_b32 v65, v8 offset:1152
    ds_read_b32 v66, v8 offset:1280
    ds_read_b32 v67, v8 offset:1408
    ds_read_b32 v68, v8 offset:1536
    ds_read_b32 v69, v8 offset:1664
    ds_read_b32 v70, v8 offset:1792
    ds_read_b32 v71, v8 offset:1920
    s_waitcnt lgkmcnt(0)
    v_pk_add_f32 v[64:65], v[64:65], v[66:67]
    v_pk_add_f32 v[68:69], v[68:69], v[70:71]
    v_pk_add_f32 v[160:161], v[64:65], v[68:69]
    v_mul_f32 v160, 0x3b124925, v160
    v_mul_f32 v161, 0x3b124925, v161
    v_fma_f32 v161, -v160, v160, v161
    v_max_f32 v161, 0, v161
    v_add_f32 v161, 0x3727c5ac, v161
    v_sqrt_f32 v2, v161
    v_rcp_f32 v161, v161
    v_cvt_pk_bf16_f32 v160, -v160, v2
    buffer_store_dwordx4 v[160:163], v9, s[16:19], s23 offen offset:1024 sc1
    s_endpgm
L_exit:
    s_endpgm
L_end:
.section .rodata,"a"
.p2align 6
.amdhsa_kernel adaLN_cond__ssm_conv_h3__glu_gated_reglu__prompt_kernel
  .amdhsa_next_free_vgpr 512
  .amdhsa_next_free_sgpr 102
  .amdhsa_accum_offset 256
  .amdhsa_group_segment_fixed_size 0
  .amdhsa_kernarg_size 120
  .amdhsa_user_sgpr_count 2
  .amdhsa_user_sgpr_kernarg_segment_ptr 1
  .amdhsa_system_sgpr_workgroup_id_x 1
  .amdhsa_float_denorm_mode_32 3
.end_amdhsa_kernel
```
